```python
import torch

def _softmax(x, axis=-1):
    return torch.softmax(x, dim=axis)
def _gelu(x):
    return torch.nn.functional.gelu(x, approximate="tanh")
def _silu(x):
    return torch.nn.functional.silu(x)
def _sigmoid(x):
    return torch.sigmoid(x)
def _layernorm(x, axis=-1, eps=1e-5):
    m = x.mean(dim=axis, keepdim=True)
    v = x.var(dim=axis, keepdim=True, unbiased=False)
    return (x - m) / torch.sqrt(v + eps)
def _scatter_add(tgt, idx, src, axis=0):
    return tgt.clone().index_add_(axis, idx, src)
def _segment_sum(src, seg, n):
    out = torch.zeros((n,) + src.shape[1:], dtype=src.dtype)
    return out.index_add_(0, seg, src)
def _pad(x, pw):
    flat = tuple(v for pair in reversed(pw) for v in pair)
    return torch.nn.functional.pad(x, flat)

kernel_name = 'gated_mix__grouped_kv_mqa__glu_gated_bilinear__prompt'

def setup_inputs():

    _w = (lambda a: (lambda t: t.to(torch.bfloat16) if t.is_floating_point() else t)(torch.as_tensor(a)))
    def _A_setup():
        B, S, D, H = 1, 2048, 448, 16
        Dh = D // H
        return {
            "x": _w((lambda *s: torch.randn(*s, dtype=torch.bfloat16) * 0.05)(B, S, D)),
            "wq": _w((lambda *s: torch.randn(*s, dtype=torch.bfloat16) * 0.8)(D, H * Dh)),
            "wk": _w((lambda *s: torch.randn(*s, dtype=torch.bfloat16) * 0.8)(D, Dh)),
            "wv": _w((lambda *s: torch.randn(*s, dtype=torch.bfloat16) * 0.05)(D, Dh)),
            "wo": _w((lambda *s: torch.randn(*s, dtype=torch.bfloat16) * 0.05)(H * Dh, D)),
        }
    _A_in = _A_setup()

    def _B_setup():
        B, S, D, F = 1, 2048, 448, 1792
        return {
            "x": _w((lambda *s: torch.randn(*s, dtype=torch.bfloat16) * 0.05)(B, S, D)),
            "w_gate": _w((lambda *s: torch.randn(*s, dtype=torch.bfloat16) * 0.8)(D, F) * (D ** -0.5)),
            "w_up": _w((lambda *s: torch.randn(*s, dtype=torch.bfloat16) * 0.8)(D, F) * (D ** -0.5)),
            "w_down": _w((lambda *s: torch.randn(*s, dtype=torch.bfloat16) * 0.8)(F, D) * (F ** -0.5)),
        }
    _B_in = _B_setup()

    return {
        "A_x": _A_in["x"],
        "A_wq": _A_in["wq"],
        "A_wk": _A_in["wk"],
        "A_wv": _A_in["wv"],
        "A_wo": _A_in["wo"],
        "B_x": _B_in["x"],
        "B_w_gate": _B_in["w_gate"],
        "B_w_up": _B_in["w_up"],
        "B_w_down": _B_in["w_down"],
        "gate_w": _w((lambda *s: torch.randn(*s, dtype=torch.bfloat16) * 0.05)(448) * 16.0),
    }

def reference(A_x, A_wq, A_wk, A_wv, A_wo, B_x, B_w_gate, B_w_up, B_w_down, gate_w):
    def _A_ref(x, wq, wk, wv, wo):
        B, S, D = x.shape
        H = 16
        Dh = D // H
        q = (lambda x, *d: x.permute(*d))((x @ wq).reshape(B, S, H, Dh), 0, 2, 1, 3)
        k = x @ wk
        v = x @ wv
        scores = torch.einsum("bhqd,bkd->bhqk", q, k) * (Dh ** -0.5)
        p = _softmax(scores, axis=-1)
        o = torch.einsum("bhqk,bkd->bhqd", p, v)
        return (lambda x, *d: x.permute(*d))(o, 0, 2, 1, 3).reshape(B, S, H * Dh) @ wo

    def _B_ref(x, w_gate, w_up, w_down):
        g = torch.einsum("bsd,df->bsf", x, w_gate)
        u = torch.einsum("bsd,df->bsf", x, w_up)
        h = g * u
        return torch.einsum("bsf,fd->bsd", h, w_down)

    x = A_x
    g = _sigmoid((x * gate_w).sum(-1, keepdims=True))
    a = _A_ref(x, A_wq, A_wk, A_wv, A_wo)
    b = _B_ref(x, B_w_gate, B_w_up, B_w_down)
    return g * a + (1 - g) * b
```

```asm
; @launch grid=(256,1,1) block=(512,1,1) lds=163840
.amdgcn_target "amdgcn-amd-amdhsa--gfx950"
.text
.globl gated_mix__grouped_kv_mqa__glu_gated_bilinear__prompt_kernel
.p2align 8
.type gated_mix__grouped_kv_mqa__glu_gated_bilinear__prompt_kernel,@function
gated_mix__grouped_kv_mqa__glu_gated_bilinear__prompt_kernel:
    s_cmp_ge_u32 s2, 256
    s_cbranch_scc1 L_end
    s_load_dwordx2 s[4:5], s[0:1], 0
    s_load_dwordx2 s[28:29], s[0:1], 96
    s_load_dwordx2 s[36:37], s[0:1], 88
    v_lshrrev_b32 v1, 6, v0
    v_and_b32 v0, 63, v0
    v_readfirstlane_b32 s44, v1
    s_and_b32 s68, s2, 7
    s_lshr_b32 s69, s2, 3
    s_getpc_b64 s[52:53]
L_pc:
    s_lshl_b32 s70, s69, 3
    s_add_u32 s70, s70, s44
    s_lshl_b32 s70, s70, 7
    s_min_u32 s70, s70, L_end-L_pc
    v_mov_b32 v1, s70
    s_mov_b64 exec, 1
    global_load_dword v63, v1, s[52:53]
    s_mov_b64 exec, -1
    s_and_b32 s46, s68, 3
    s_lshl_b32 s46, s46, 2
    s_and_b32 s70, s69, 3
    s_add_u32 s46, s46, s70
    s_lshr_b32 s49, s69, 2
    s_lshr_b32 s70, s68, 2
    s_mul_i32 s47, s70, 7
    s_add_u32 s47, s47, s49
    s_sub_u32 s47, s47, 1
    s_add_u32 s71, s70, 14
    s_cmp_eq_u32 s49, 0
    s_cselect_b32 s47, s71, s47
    s_cmp_eq_u32 s70, 0
    s_mov_b32 s50, 0x76543102
    s_cselect_b32 s50, s50, 0xfecba98d
    s_and_b32 s70, s69, 28
    s_lshr_b32 s50, s50, s70
    s_and_b32 s50, s50, 15
    s_and_b32 s45, s44, 3
    s_mov_b32 s6, 1835008
    s_mov_b32 s7, 0x20000
    s_mov_b32 s30, 10485760
    s_mov_b32 s31, 0x20000
    s_mov_b32 s38, 256
    s_mov_b32 s39, 0x20000
    v_lshlrev_b32 v29, 4, v0
    v_lshrrev_b32 v31, 5, v0
    s_cmp_ge_u32 s44, 4
    s_cbranch_scc1 L_g
    s_load_dwordx2 s[8:9], s[0:1], 8
    s_mov_b32 s10, 401408
    s_mov_b32 s11, 0x20000
    s_mov_b32 s15, 0x20000
    s_mov_b32 s19, 0x20000
    s_cmp_ge_u32 s47, 14
    s_cbranch_scc1 L_ak
L_af:
    s_load_dwordx2 s[12:13], s[0:1], 48
    s_load_dwordx2 s[16:17], s[0:1], 56
    s_mov_b32 s14, 1605632
    s_mov_b32 s18, 1605632
    s_xor_b32 s58, s69, s49
    s_and_b32 s58, s58, 1
    s_and_b32 s60, s69, 2
    s_add_u32 s60, s60, s45
    s_and_b32 s60, s60, 3
    s_lshr_b32 s70, s69, 3
    s_add_u32 s61, s45, s70
    s_and_b32 s61, s61, 3
    s_lshl_b32 s59, s61, 12
    s_lshl_b32 s51, s60, 11
    v_lshrrev_b32 v24, 4, v0
    v_and_b32 v25, 7, v0
    v_xor_b32 v25, v25, v24
    v_lshlrev_b32 v25, 4, v25
    v_lshrrev_b32 v26, 3, v0
    v_mul_u32_u24 v26, 896, v26
    v_add_u32 v1, v26, v25
    v_xor_b32 v25, 64, v25
    v_add_u32 v2, v26, v25
    v_add_u32 v2, 6144, v2
    v_add_u32 v3, 12288, v1
    v_add_u32 v4, 12288, v2
    s_lshl_b32 s52, s46, 2
    s_add_u32 s52, s52, s61
    s_mul_i32 s52, s52, 28672
    s_lshl_b32 s55, s45, 12
    v_and_b32 v25, 15, v0
    v_lshlrev_b32 v26, 1, v24
    v_xor_b32 v25, v25, v26
    v_lshlrev_b32 v25, 4, v25
    v_mul_u32_u24 v26, 3584, v24
    v_add_u32 v5, v26, v25
    v_xor_b32 v7, 128, v5
    v_add_u32 v6, 13312, v5
    v_add_u32 v8, 13312, v7
    s_mul_i32 s53, s60, 28672
    s_lshl_b32 s70, s47, 8
    s_add_u32 s53, s53, s70
    s_waitcnt lgkmcnt(0)
    s_xor_b32 s64, s58, 0
    s_add_u32 m0, s59, 106496
    s_lshl_b32 s65, s64, 7
    s_add_u32 s65, s65, s52
    buffer_load_dwordx4 v1, s[4:7], s65 offen offset:0 lds
    buffer_load_dwordx4 v2, s[4:7], s65 offen offset:1024 lds
    buffer_load_dwordx4 v3, s[4:7], s65 offen offset:2048 lds
    buffer_load_dwordx4 v4, s[4:7], s65 offen offset:3072 lds
    s_xor_b32 s64, s58, 0
    s_add_u32 m0, s51, 122880
    s_mul_i32 s65, s64, 229376
    s_add_u32 s65, s65, s53
    buffer_load_dwordx4 v5, s[12:15], s65 offen offset:0 lds
    buffer_load_dwordx4 v6, s[12:15], s65 offen offset:1024 lds
    s_add_u32 m0, s51, 139264
    s_nop 0
    buffer_load_dwordx4 v7, s[16:19], s65 offen offset:0 lds
    buffer_load_dwordx4 v8, s[16:19], s65 offen offset:1024 lds
    v_lshrrev_b32 v25, 2, v0
    v_mul_u32_u24 v25, 896, v25
    v_and_b32 v26, 3, v0
    v_lshl_add_u32 v13, v26, 4, v25
    s_mul_i32 s57, s50, 56
    s_and_b32 s54, s57, 0xfffffff0
    s_mul_i32 s70, s60, 14336
    s_add_u32 s54, s54, s70
    s_and_b32 s57, s57, 8
    s_lshl_b32 s56, s60, 10
    s_barrier
    s_xor_b32 s64, s58, 0
    s_add_u32 m0, s51, 131072
    s_mul_i32 s65, s64, 229376
    s_add_u32 s65, s65, s53
    s_add_u32 s65, s65, 114688
    buffer_load_dwordx4 v5, s[12:15], s65 offen offset:0 lds
    buffer_load_dwordx4 v6, s[12:15], s65 offen offset:1024 lds
    s_add_u32 m0, s51, 147456
    s_nop 0
    buffer_load_dwordx4 v7, s[16:19], s65 offen offset:0 lds
    buffer_load_dwordx4 v8, s[16:19], s65 offen offset:1024 lds
    s_xor_b32 s64, s58, 0
    s_add_u32 m0, s56, 155648
    s_mul_i32 s65, s64, 57344
    s_add_u32 s65, s65, s54
    buffer_load_dwordx4 v13, s[8:11], s65 offen lds
    v_and_b32 v24, 31, v0
    v_bfe_u32 v25, v0, 1, 3
    v_xor_b32 v25, v25, v31
    v_lshlrev_b32 v25, 4, v25
    v_lshl_add_u32 v30, v24, 7, v25
    v_bfe_u32 v28, v0, 2, 2
    v_bfe_u32 v24, v0, 4, 1
    v_and_b32 v25, 3, v0
    v_lshlrev_b32 v25, 3, v25
    v_lshl_add_u32 v27, v24, 5, v25
    v_add_u32 v14, s55, v30
    v_xor_b32 v15, 32, v14
    v_xor_b32 v16, 64, v14
    v_xor_b32 v17, 96, v14
    v_lshl_add_u32 v25, v31, 3, v28
    v_lshl_add_u32 v18, v25, 6, v27
    v_add_u32 v18, s57, v18
    v_add_u32 v19, 0x10000, v14
    v_add_u32 v88, 0x20000, v14
    v_add_u32 v20, 0x10000, v15
    v_add_u32 v89, 0x20000, v15
    v_add_u32 v21, 0x10000, v16
    v_add_u32 v90, 0x20000, v16
    v_add_u32 v22, 0x10000, v17
    v_add_u32 v91, 0x20000, v17
    v_add_u32 v23, 0x10000, v18
    v_add_u32 v92, 0x20000, v18
    v_mov_b32 v24, 163792
    v_mov_b32 v94, 0
    v_mov_b32 v95, 0
    ds_write_b64 v24, v[94:95] offset:0
    ds_write_b64 v24, v[94:95] offset:8
    ds_write_b64 v24, v[94:95] offset:16
    ds_write_b64 v24, v[94:95] offset:24
    ds_write_b64 v24, v[94:95] offset:32
    ds_write_b64 v24, v[94:95] offset:40
    s_lshl_b32 s70, s45, 16
    s_add_u32 s40, s28, s70
    s_addc_u32 s41, s29, 0
    s_waitcnt lgkmcnt(0)
    s_xor_b32 s64, s58, 1
    s_add_u32 m0, s59, 0
    s_lshl_b32 s65, s64, 7
    s_add_u32 s65, s65, s52
    buffer_load_dwordx4 v1, s[4:7], s65 offen offset:0 lds
    buffer_load_dwordx4 v2, s[4:7], s65 offen offset:1024 lds
    buffer_load_dwordx4 v3, s[4:7], s65 offen offset:2048 lds
    buffer_load_dwordx4 v4, s[4:7], s65 offen offset:3072 lds
    s_waitcnt vmcnt(9)
    s_barrier
    s_xor_b32 s64, s58, 1
    s_add_u32 m0, s51, 16384
    s_mul_i32 s65, s64, 229376
    s_add_u32 s65, s65, s53
    buffer_load_dwordx4 v5, s[12:15], s65 offen offset:0 lds
    buffer_load_dwordx4 v6, s[12:15], s65 offen offset:1024 lds
    s_add_u32 m0, s51, 32768
    s_nop 0
    buffer_load_dwordx4 v7, s[16:19], s65 offen offset:0 lds
    buffer_load_dwordx4 v8, s[16:19], s65 offen offset:1024 lds
    s_waitcnt vmcnt(8)
    s_barrier
    ds_read_b128 v[48:51], v19 offset:40960
    ds_read_b64_tr_b16 v[64:65], v92 offset:24576
    ds_read_b64_tr_b16 v[66:67], v92 offset:24832
    ds_read_b128 v[52:55], v20 offset:40960
    ds_read_b64_tr_b16 v[68:69], v92 offset:25600
    ds_read_b64_tr_b16 v[70:71], v92 offset:25856
    ds_read_b128 v[56:59], v21 offset:40960
    ds_read_b64_tr_b16 v[72:73], v92 offset:26624
    ds_read_b64_tr_b16 v[74:75], v92 offset:26880
    ds_read_b128 v[60:63], v22 offset:40960
    ds_read_b64_tr_b16 v[76:77], v92 offset:27648
    ds_read_b64_tr_b16 v[78:79], v92 offset:27904
    s_xor_b32 s64, s58, 1
    s_add_u32 m0, s51, 24576
    s_mul_i32 s65, s64, 229376
    s_add_u32 s65, s65, s53
    s_add_u32 s65, s65, 114688
    buffer_load_dwordx4 v5, s[12:15], s65 offen offset:0 lds
    buffer_load_dwordx4 v6, s[12:15], s65 offen offset:1024 lds
    s_add_u32 m0, s51, 40960
    s_nop 0
    buffer_load_dwordx4 v7, s[16:19], s65 offen offset:0 lds
    buffer_load_dwordx4 v8, s[16:19], s65 offen offset:1024 lds
    s_waitcnt lgkmcnt(9)
    v_mfma_f32_32x32x16_bf16 v[32:47], v[64:67], v[48:51], 0
    s_xor_b32 s64, s58, 1
    s_add_u32 m0, s56, 49152
    s_mul_i32 s65, s64, 57344
    s_add_u32 s65, s65, s54
    buffer_load_dwordx4 v13, s[8:11], s65 offen lds
    s_waitcnt lgkmcnt(6)
    v_mfma_f32_32x32x16_bf16 v[32:47], v[68:71], v[52:55], v[32:47]
    s_xor_b32 s64, s58, 2
    s_add_u32 m0, s59, 53248
    s_lshl_b32 s65, s64, 7
    s_add_u32 s65, s65, s52
    buffer_load_dwordx4 v1, s[4:7], s65 offen offset:0 lds
    buffer_load_dwordx4 v2, s[4:7], s65 offen offset:1024 lds
    buffer_load_dwordx4 v3, s[4:7], s65 offen offset:2048 lds
    buffer_load_dwordx4 v4, s[4:7], s65 offen offset:3072 lds
    s_waitcnt lgkmcnt(3)
    v_mfma_f32_32x32x16_bf16 v[32:47], v[72:75], v[56:59], v[32:47]
    s_waitcnt lgkmcnt(0)
    v_mfma_f32_32x32x16_bf16 v[32:47], v[76:79], v[60:63], v[32:47]
    s_waitcnt vmcnt(4)
    s_barrier
    s_xor_b32 s64, s58, 2
    s_add_u32 m0, s51, 69632
    s_mul_i32 s65, s64, 229376
    s_add_u32 s65, s65, s53
    buffer_load_dwordx4 v5, s[12:15], s65 offen offset:0 lds
    buffer_load_dwordx4 v6, s[12:15], s65 offen offset:1024 lds
    s_add_u32 m0, s51, 86016
    s_nop 0
    buffer_load_dwordx4 v7, s[16:19], s65 offen offset:0 lds
    buffer_load_dwordx4 v8, s[16:19], s65 offen offset:1024 lds
    ds_read_b128 v[48:51], v14 offset:0
    ds_read_b64_tr_b16 v[64:65], v18 offset:49152
    ds_read_b64_tr_b16 v[66:67], v18 offset:49408
    ds_read_b128 v[52:55], v15 offset:0
    ds_read_b64_tr_b16 v[68:69], v18 offset:50176
    ds_read_b64_tr_b16 v[70:71], v18 offset:50432
    ds_read_b128 v[56:59], v16 offset:0
    ds_read_b64_tr_b16 v[72:73], v18 offset:51200
    ds_read_b64_tr_b16 v[74:75], v18 offset:51456
    ds_read_b128 v[60:63], v17 offset:0
    ds_read_b64_tr_b16 v[76:77], v18 offset:52224
    ds_read_b64_tr_b16 v[78:79], v18 offset:52480
    s_xor_b32 s64, s58, 2
    s_add_u32 m0, s51, 77824
    s_mul_i32 s65, s64, 229376
    s_add_u32 s65, s65, s53
    s_add_u32 s65, s65, 114688
    buffer_load_dwordx4 v5, s[12:15], s65 offen offset:0 lds
    buffer_load_dwordx4 v6, s[12:15], s65 offen offset:1024 lds
    s_add_u32 m0, s51, 94208
    s_nop 0
    buffer_load_dwordx4 v7, s[16:19], s65 offen offset:0 lds
    buffer_load_dwordx4 v8, s[16:19], s65 offen offset:1024 lds
    s_waitcnt lgkmcnt(9)
    v_mfma_f32_32x32x16_bf16 v[32:47], v[64:67], v[48:51], v[32:47]
    s_xor_b32 s64, s58, 2
    s_add_u32 m0, s56, 102400
    s_mul_i32 s65, s64, 57344
    s_add_u32 s65, s65, s54
    buffer_load_dwordx4 v13, s[8:11], s65 offen lds
    s_waitcnt lgkmcnt(6)
    v_mfma_f32_32x32x16_bf16 v[32:47], v[68:71], v[52:55], v[32:47]
    s_xor_b32 s64, s58, 3
    s_add_u32 m0, s59, 106496
    s_lshl_b32 s65, s64, 7
    s_add_u32 s65, s65, s52
    buffer_load_dwordx4 v1, s[4:7], s65 offen offset:0 lds
    buffer_load_dwordx4 v2, s[4:7], s65 offen offset:1024 lds
    buffer_load_dwordx4 v3, s[4:7], s65 offen offset:2048 lds
    buffer_load_dwordx4 v4, s[4:7], s65 offen offset:3072 lds
    s_waitcnt lgkmcnt(3)
    v_mfma_f32_32x32x16_bf16 v[32:47], v[72:75], v[56:59], v[32:47]
    s_xor_b32 s64, s58, 3
    s_add_u32 m0, s51, 122880
    s_mul_i32 s65, s64, 229376
    s_add_u32 s65, s65, s53
    buffer_load_dwordx4 v5, s[12:15], s65 offen offset:0 lds
    buffer_load_dwordx4 v6, s[12:15], s65 offen offset:1024 lds
    s_add_u32 m0, s51, 139264
    s_nop 0
    buffer_load_dwordx4 v7, s[16:19], s65 offen offset:0 lds
    buffer_load_dwordx4 v8, s[16:19], s65 offen offset:1024 lds
    s_waitcnt lgkmcnt(0)
    v_mfma_f32_32x32x16_bf16 v[32:47], v[76:79], v[60:63], v[32:47]
    s_waitcnt vmcnt(8)
    s_barrier
    s_xor_b32 s64, s58, 3
    s_add_u32 m0, s51, 131072
    s_mul_i32 s65, s64, 229376
    s_add_u32 s65, s65, s53
    s_add_u32 s65, s65, 114688
    buffer_load_dwordx4 v5, s[12:15], s65 offen offset:0 lds
    buffer_load_dwordx4 v6, s[12:15], s65 offen offset:1024 lds
    s_add_u32 m0, s51, 147456
    s_nop 0
    buffer_load_dwordx4 v7, s[16:19], s65 offen offset:0 lds
    buffer_load_dwordx4 v8, s[16:19], s65 offen offset:1024 lds
    ds_read_b128 v[48:51], v14 offset:53248
    ds_read_b64_tr_b16 v[64:65], v23 offset:36864
    ds_read_b64_tr_b16 v[66:67], v23 offset:37120
    ds_read_b128 v[52:55], v15 offset:53248
    ds_read_b64_tr_b16 v[68:69], v23 offset:37888
    ds_read_b64_tr_b16 v[70:71], v23 offset:38144
    ds_read_b128 v[56:59], v16 offset:53248
    ds_read_b64_tr_b16 v[72:73], v23 offset:38912
    ds_read_b64_tr_b16 v[74:75], v23 offset:39168
    ds_read_b128 v[60:63], v17 offset:53248
    ds_read_b64_tr_b16 v[76:77], v23 offset:39936
    ds_read_b64_tr_b16 v[78:79], v23 offset:40192
    s_xor_b32 s64, s58, 3
    s_add_u32 m0, s56, 155648
    s_mul_i32 s65, s64, 57344
    s_add_u32 s65, s65, s54
    buffer_load_dwordx4 v13, s[8:11], s65 offen lds
    s_waitcnt lgkmcnt(9)
    v_mfma_f32_32x32x16_bf16 v[32:47], v[64:67], v[48:51], v[32:47]
    s_xor_b32 s64, s58, 4
    s_add_u32 m0, s59, 0
    s_lshl_b32 s65, s64, 7
    s_add_u32 s65, s65, s52
    buffer_load_dwordx4 v1, s[4:7], s65 offen offset:0 lds
    buffer_load_dwordx4 v2, s[4:7], s65 offen offset:1024 lds
    buffer_load_dwordx4 v3, s[4:7], s65 offen offset:2048 lds
    buffer_load_dwordx4 v4, s[4:7], s65 offen offset:3072 lds
    s_waitcnt lgkmcnt(6)
    v_mfma_f32_32x32x16_bf16 v[32:47], v[68:71], v[52:55], v[32:47]
    s_xor_b32 s64, s58, 4
    s_add_u32 m0, s51, 16384
    s_mul_i32 s65, s64, 229376
    s_add_u32 s65, s65, s53
    buffer_load_dwordx4 v5, s[12:15], s65 offen offset:0 lds
    buffer_load_dwordx4 v6, s[12:15], s65 offen offset:1024 lds
    s_add_u32 m0, s51, 32768
    s_nop 0
    buffer_load_dwordx4 v7, s[16:19], s65 offen offset:0 lds
    buffer_load_dwordx4 v8, s[16:19], s65 offen offset:1024 lds
    s_waitcnt lgkmcnt(3)
    v_mfma_f32_32x32x16_bf16 v[32:47], v[72:75], v[56:59], v[32:47]
    s_xor_b32 s64, s58, 4
    s_add_u32 m0, s51, 24576
    s_mul_i32 s65, s64, 229376
    s_add_u32 s65, s65, s53
    s_add_u32 s65, s65, 114688
    buffer_load_dwordx4 v5, s[12:15], s65 offen offset:0 lds
    buffer_load_dwordx4 v6, s[12:15], s65 offen offset:1024 lds
    s_add_u32 m0, s51, 40960
    s_nop 0
    buffer_load_dwordx4 v7, s[16:19], s65 offen offset:0 lds
    buffer_load_dwordx4 v8, s[16:19], s65 offen offset:1024 lds
    s_waitcnt lgkmcnt(0)
    v_mfma_f32_32x32x16_bf16 v[32:47], v[76:79], v[60:63], v[32:47]
    v_mov_b32 v128, 0
    v_mov_b32 v129, 0
    v_mov_b32 v130, 0
    v_mov_b32 v131, 0
    v_mov_b32 v132, 0
    v_mov_b32 v133, 0
    v_mov_b32 v134, 0
    v_mov_b32 v135, 0
    v_mov_b32 v136, 0
    v_mov_b32 v137, 0
    v_mov_b32 v138, 0
    v_mov_b32 v139, 0
    v_mov_b32 v140, 0
    v_mov_b32 v141, 0
    v_mov_b32 v142, 0
    v_mov_b32 v143, 0
    v_mov_b32 v144, 0
    v_mov_b32 v145, 0
    v_mov_b32 v146, 0
    v_mov_b32 v147, 0
    v_mov_b32 v148, 0
    v_mov_b32 v149, 0
    v_mov_b32 v150, 0
    v_mov_b32 v151, 0
    v_mov_b32 v152, 0
    v_mov_b32 v153, 0
    v_mov_b32 v154, 0
    v_mov_b32 v155, 0
    s_waitcnt vmcnt(12)
    s_barrier
    s_xor_b32 s64, s58, 4
    s_add_u32 m0, s56, 49152
    s_mul_i32 s65, s64, 57344
    s_add_u32 s65, s65, s54
    buffer_load_dwordx4 v13, s[8:11], s65 offen lds
    ds_read_b128 v[48:51], v19 offset:40960
    ds_read_b64_tr_b16 v[64:65], v92 offset:24576
    ds_read_b64_tr_b16 v[66:67], v92 offset:24832
    ds_read_b128 v[52:55], v20 offset:40960
    ds_read_b64_tr_b16 v[68:69], v92 offset:25600
    ds_read_b64_tr_b16 v[70:71], v92 offset:25856
    ds_read_b128 v[56:59], v21 offset:40960
    ds_read_b64_tr_b16 v[72:73], v92 offset:26624
    ds_read_b64_tr_b16 v[74:75], v92 offset:26880
    ds_read_b128 v[60:63], v22 offset:40960
    ds_read_b64_tr_b16 v[76:77], v92 offset:27648
    ds_read_b64_tr_b16 v[78:79], v92 offset:27904
    s_xor_b32 s64, s58, 5
    s_add_u32 m0, s59, 53248
    s_lshl_b32 s65, s64, 7
    s_add_u32 s65, s65, s52
    buffer_load_dwordx4 v1, s[4:7], s65 offen offset:0 lds
    buffer_load_dwordx4 v2, s[4:7], s65 offen offset:1024 lds
    buffer_load_dwordx4 v3, s[4:7], s65 offen offset:2048 lds
    buffer_load_dwordx4 v4, s[4:7], s65 offen offset:3072 lds
    s_waitcnt lgkmcnt(9)
    v_mfma_f32_32x32x16_bf16 v[32:47], v[64:67], v[48:51], v[32:47]
    s_xor_b32 s64, s58, 5
    s_add_u32 m0, s51, 69632
    s_mul_i32 s65, s64, 229376
    s_add_u32 s65, s65, s53
    buffer_load_dwordx4 v5, s[12:15], s65 offen offset:0 lds
    buffer_load_dwordx4 v6, s[12:15], s65 offen offset:1024 lds
    s_add_u32 m0, s51, 86016
    s_nop 0
    buffer_load_dwordx4 v7, s[16:19], s65 offen offset:0 lds
    buffer_load_dwordx4 v8, s[16:19], s65 offen offset:1024 lds
    s_waitcnt lgkmcnt(6)
    v_mfma_f32_32x32x16_bf16 v[32:47], v[68:71], v[52:55], v[32:47]
    s_xor_b32 s64, s58, 5
    s_add_u32 m0, s51, 77824
    s_mul_i32 s65, s64, 229376
    s_add_u32 s65, s65, s53
    s_add_u32 s65, s65, 114688
    buffer_load_dwordx4 v5, s[12:15], s65 offen offset:0 lds
    buffer_load_dwordx4 v6, s[12:15], s65 offen offset:1024 lds
    s_add_u32 m0, s51, 94208
    s_nop 0
    buffer_load_dwordx4 v7, s[16:19], s65 offen offset:0 lds
    buffer_load_dwordx4 v8, s[16:19], s65 offen offset:1024 lds
    s_waitcnt lgkmcnt(3)
    v_mfma_f32_32x32x16_bf16 v[32:47], v[72:75], v[56:59], v[32:47]
    s_xor_b32 s64, s58, 5
    s_add_u32 m0, s56, 102400
    s_mul_i32 s65, s64, 57344
    s_add_u32 s65, s65, s54
    buffer_load_dwordx4 v13, s[8:11], s65 offen lds
    s_waitcnt lgkmcnt(0)
    v_mfma_f32_32x32x16_bf16 v[32:47], v[76:79], v[60:63], v[32:47]
    v_mov_b32 v156, 0
    v_mov_b32 v157, 0
    v_mov_b32 v158, 0
    v_mov_b32 v159, 0
    v_mov_b32 v160, 0
    v_mov_b32 v161, 0
    v_mov_b32 v162, 0
    v_mov_b32 v163, 0
    v_mov_b32 v164, 0
    v_mov_b32 v165, 0
    v_mov_b32 v166, 0
    v_mov_b32 v167, 0
    v_mov_b32 v168, 0
    v_mov_b32 v169, 0
    v_mov_b32 v170, 0
    v_mov_b32 v171, 0
    v_mov_b32 v172, 0
    v_mov_b32 v173, 0
    v_mov_b32 v174, 0
    v_mov_b32 v175, 0
    v_mov_b32 v176, 0
    v_mov_b32 v177, 0
    v_mov_b32 v178, 0
    v_mov_b32 v179, 0
    v_mov_b32 v180, 0
    v_mov_b32 v181, 0
    v_mov_b32 v182, 0
    v_mov_b32 v183, 0
    s_waitcnt vmcnt(13)
    s_barrier
    ds_read_b128 v[48:51], v14 offset:0
    ds_read_b64_tr_b16 v[64:65], v18 offset:49152
    ds_read_b64_tr_b16 v[66:67], v18 offset:49408
    ds_read_b128 v[52:55], v15 offset:0
    ds_read_b64_tr_b16 v[68:69], v18 offset:50176
    ds_read_b64_tr_b16 v[70:71], v18 offset:50432
    ds_read_b128 v[56:59], v16 offset:0
    ds_read_b64_tr_b16 v[72:73], v18 offset:51200
    ds_read_b64_tr_b16 v[74:75], v18 offset:51456
    ds_read_b128 v[60:63], v17 offset:0
    ds_read_b64_tr_b16 v[76:77], v18 offset:52224
    ds_read_b64_tr_b16 v[78:79], v18 offset:52480
    s_mov_b32 s64, 6
    s_add_u32 m0, s59, 106496
    s_lshl_b32 s65, s64, 7
    s_add_u32 s65, s65, s52
    buffer_load_dwordx4 v1, s[4:7], s65 offen offset:0 lds
    buffer_load_dwordx4 v2, s[4:7], s65 offen offset:1024 lds
    buffer_load_dwordx4 v3, s[4:7], s65 offen offset:2048 lds
    buffer_load_dwordx4 v4, s[4:7], s65 offen offset:3072 lds
    s_waitcnt lgkmcnt(9)
    v_mfma_f32_32x32x16_bf16 v[32:47], v[64:67], v[48:51], v[32:47]
    s_mov_b32 s64, 6
    s_add_u32 m0, s51, 122880
    s_mul_i32 s65, s64, 229376
    s_add_u32 s65, s65, s53
    buffer_load_dwordx4 v5, s[12:15], s65 offen offset:0 lds
    buffer_load_dwordx4 v6, s[12:15], s65 offen offset:1024 lds
    s_add_u32 m0, s51, 139264
    s_nop 0
    buffer_load_dwordx4 v7, s[16:19], s65 offen offset:0 lds
    buffer_load_dwordx4 v8, s[16:19], s65 offen offset:1024 lds
    s_waitcnt lgkmcnt(6)
    v_mfma_f32_32x32x16_bf16 v[32:47], v[68:71], v[52:55], v[32:47]
    s_mov_b32 s64, 6
    s_add_u32 m0, s51, 131072
    s_mul_i32 s65, s64, 229376
    s_add_u32 s65, s65, s53
    s_add_u32 s65, s65, 114688
    buffer_load_dwordx4 v5, s[12:15], s65 offen offset:0 lds
    buffer_load_dwordx4 v6, s[12:15], s65 offen offset:1024 lds
    s_add_u32 m0, s51, 147456
    s_nop 0
    buffer_load_dwordx4 v7, s[16:19], s65 offen offset:0 lds
    buffer_load_dwordx4 v8, s[16:19], s65 offen offset:1024 lds
    s_waitcnt lgkmcnt(3)
    v_mfma_f32_32x32x16_bf16 v[32:47], v[72:75], v[56:59], v[32:47]
    s_mov_b32 s64, 6
    s_add_u32 m0, s56, 155648
    s_mul_i32 s65, s64, 57344
    s_add_u32 s65, s65, s54
    buffer_load_dwordx4 v13, s[8:11], s65 offen lds
    s_waitcnt lgkmcnt(0)
    v_mfma_f32_32x32x16_bf16 v[32:47], v[76:79], v[60:63], v[32:47]
    v_mov_b32 v184, 0
    v_mov_b32 v185, 0
    v_mov_b32 v186, 0
    v_mov_b32 v187, 0
    v_mov_b32 v188, 0
    v_mov_b32 v189, 0
    v_mov_b32 v190, 0
    v_mov_b32 v191, 0
    v_mov_b32 v80, 0
    v_mov_b32 v81, 0
    v_mov_b32 v82, 0
    v_mov_b32 v83, 0
    v_mov_b32 v84, 0
    v_mov_b32 v85, 0
    v_mov_b32 v86, 0
    v_mov_b32 v87, 0
    v_mov_b32 v248, 0
    v_mov_b32 v249, 0
    v_mov_b32 v250, 0
    v_mov_b32 v251, 0
    v_mov_b32 v252, 0
    v_mov_b32 v253, 0
    v_mov_b32 v254, 0
    v_mov_b32 v255, 0
    v_and_b32 v94, 31, v0
    v_lshlrev_b32 v94, 2, v94
    s_waitcnt vmcnt(13)
    s_barrier
    buffer_load_dword v24, off, s[36:39], 0 offset:128 sc1
    ds_read_b128 v[48:51], v14 offset:53248
    ds_read_b64_tr_b16 v[64:65], v23 offset:36864
    ds_read_b64_tr_b16 v[66:67], v23 offset:37120
    ds_read_b128 v[52:55], v15 offset:53248
    ds_read_b64_tr_b16 v[68:69], v23 offset:37888
    ds_read_b64_tr_b16 v[70:71], v23 offset:38144
    ds_read_b128 v[56:59], v16 offset:53248
    ds_read_b64_tr_b16 v[72:73], v23 offset:38912
    ds_read_b64_tr_b16 v[74:75], v23 offset:39168
    ds_read_b128 v[60:63], v17 offset:53248
    ds_read_b64_tr_b16 v[76:77], v23 offset:39936
    ds_read_b64_tr_b16 v[78:79], v23 offset:40192
    s_waitcnt lgkmcnt(9)
    v_mfma_f32_32x32x16_bf16 v[32:47], v[64:67], v[48:51], v[32:47]
    s_waitcnt lgkmcnt(6)
    v_mfma_f32_32x32x16_bf16 v[32:47], v[68:71], v[52:55], v[32:47]
    s_waitcnt lgkmcnt(3)
    v_mfma_f32_32x32x16_bf16 v[32:47], v[72:75], v[56:59], v[32:47]
    s_waitcnt lgkmcnt(0)
    v_mfma_f32_32x32x16_bf16 v[32:47], v[76:79], v[60:63], v[32:47]
    s_waitcnt vmcnt(0)
    v_readfirstlane_b32 s63, v24
    s_mov_b32 s61, 0
    s_cmp_lt_u32 s63, 1
    s_cbranch_scc1 L_af_notyet
    s_lshl_b32 s70, s69, 2
    s_add_u32 s70, s70, s45
    s_lshl_b32 s70, s70, 11
    v_lshlrev_b32 v24, 7, v0
    s_mov_b32 exec_lo, 0xffff
    s_mov_b32 exec_hi, 0
    buffer_load_dword v95, v24, s[28:31], s70 offen sc1
    s_mov_b64 exec, -1
    s_lshl_b32 s70, s46, 2
    s_add_u32 s70, s70, s45
    s_lshl_b32 s70, s70, 7
    s_add_u32 s70, s70, 262144
    buffer_load_dword v93, v94, s[28:31], s70 offen sc1
    v_add_u32 v30, 4096, v29
    global_load_dwordx4 v[192:195], v30, s[40:41] offset:-4096 sc1
    global_load_dwordx4 v[196:199], v30, s[40:41] offset:-3072 sc1
    global_load_dwordx4 v[224:227], v30, s[40:41] offset:-2048 sc1
    global_load_dwordx4 v[228:231], v30, s[40:41] offset:-1024 sc1
    s_mov_b32 s61, 1
L_af_notyet:
    s_barrier
    s_setprio 3
    s_cmp_eq_u32 s61, 1
    s_cbranch_scc1 L_af_rdy
    s_mov_b32 s62, 131072
L_af_poll:
    buffer_load_dword v24, off, s[36:39], 0 offset:128 sc1
    s_waitcnt vmcnt(0)
    v_readfirstlane_b32 s63, v24
    s_sub_u32 s62, s62, 1
    s_cmp_eq_u32 s62, 0
    s_cbranch_scc1 L_af_poll_x
    s_cmp_lg_u32 s63, 0
    s_cbranch_scc1 L_af_poll_x
    s_sleep 3
    s_branch L_af_poll
L_af_poll_x:
    s_lshl_b32 s70, s69, 2
    s_add_u32 s70, s70, s45
    s_lshl_b32 s70, s70, 11
    v_lshlrev_b32 v24, 7, v0
    s_mov_b32 exec_lo, 0xffff
    s_mov_b32 exec_hi, 0
    buffer_load_dword v95, v24, s[28:31], s70 offen sc1
    s_mov_b64 exec, -1
    s_lshl_b32 s70, s46, 2
    s_add_u32 s70, s70, s45
    s_lshl_b32 s70, s70, 7
    s_add_u32 s70, s70, 262144
    buffer_load_dword v93, v94, s[28:31], s70 offen sc1
    v_add_u32 v30, 4096, v29
    global_load_dwordx4 v[192:195], v30, s[40:41] offset:-4096 sc1
    global_load_dwordx4 v[196:199], v30, s[40:41] offset:-3072 sc1
    global_load_dwordx4 v[224:227], v30, s[40:41] offset:-2048 sc1
    global_load_dwordx4 v[228:231], v30, s[40:41] offset:-1024 sc1
L_af_rdy:
    ds_read_b128 v[48:51], v19 offset:40960
    ds_read_b64_tr_b16 v[64:65], v92 offset:24576
    ds_read_b64_tr_b16 v[66:67], v92 offset:24832
    ds_read_b128 v[52:55], v20 offset:40960
    ds_read_b64_tr_b16 v[68:69], v92 offset:25600
    ds_read_b64_tr_b16 v[70:71], v92 offset:25856
    ds_read_b128 v[56:59], v21 offset:40960
    ds_read_b64_tr_b16 v[72:73], v92 offset:26624
    ds_read_b64_tr_b16 v[74:75], v92 offset:26880
    ds_read_b128 v[60:63], v22 offset:40960
    ds_read_b64_tr_b16 v[76:77], v92 offset:27648
    ds_read_b64_tr_b16 v[78:79], v92 offset:27904
    global_load_dwordx4 v[200:203], v30, s[40:41] offset:0 sc1
    global_load_dwordx4 v[204:207], v30, s[40:41] offset:1024 sc1
    global_load_dwordx4 v[232:235], v30, s[40:41] offset:2048 sc1
    global_load_dwordx4 v[236:239], v30, s[40:41] offset:3072 sc1
    v_add_u32 v30, 8192, v30
    s_waitcnt lgkmcnt(9)
    v_mfma_f32_32x32x16_bf16 v[32:47], v[64:67], v[48:51], v[32:47]
    s_waitcnt lgkmcnt(6)
    v_mfma_f32_32x32x16_bf16 v[32:47], v[68:71], v[52:55], v[32:47]
    global_load_dwordx4 v[208:211], v30, s[40:41] offset:-4096 sc1
    global_load_dwordx4 v[212:215], v30, s[40:41] offset:-3072 sc1
    global_load_dwordx4 v[240:243], v30, s[40:41] offset:-2048 sc1
    global_load_dwordx4 v[244:247], v30, s[40:41] offset:-1024 sc1
    s_waitcnt lgkmcnt(3)
    v_mfma_f32_32x32x16_bf16 v[32:47], v[72:75], v[56:59], v[32:47]
    s_waitcnt lgkmcnt(0)
    v_mfma_f32_32x32x16_bf16 v[32:47], v[76:79], v[60:63], v[32:47]
    s_mov_b32 s58, 98304
    s_branch L_attn
L_ak:
    s_load_dwordx2 s[16:17], s[0:1], 72
    s_cmp_eq_u32 s47, 14
    s_cbranch_scc1 L_ak_k
    s_load_dwordx2 s[12:13], s[0:1], 24
    s_branch L_ak_j
L_ak_k:
    s_load_dwordx2 s[12:13], s[0:1], 16
L_ak_j:
    s_mov_b32 s14, 25088
    s_mov_b32 s18, 896
    s_lshl_b32 s55, s45, 12
    v_lshrrev_b32 v25, 2, v0
    v_mul_u32_u24 v25, 896, v25
    v_and_b32 v26, 3, v0
    v_lshl_add_u32 v13, v26, 4, v25
    s_mul_i32 s57, s50, 56
    s_and_b32 s54, s57, 0xfffffff0
    s_mul_i32 s70, s45, 14336
    s_add_u32 s54, s54, s70
    s_and_b32 s57, s57, 8
    s_lshl_b32 s56, s45, 10
    s_waitcnt lgkmcnt(0)
    s_add_u32 s53, s56, 122880
    s_mov_b32 s70, s56
    s_mov_b32 m0, s53
    s_add_u32 s53, s53, 4096
    buffer_load_dwordx4 v29, s[12:15], s70 offen lds
    s_add_u32 s70, s70, 4096
    s_mov_b32 m0, s53
    s_add_u32 s53, s53, 4096
    buffer_load_dwordx4 v29, s[12:15], s70 offen lds
    s_add_u32 s70, s70, 4096
    s_mov_b32 m0, s53
    s_add_u32 s53, s53, 4096
    buffer_load_dwordx4 v29, s[12:15], s70 offen lds
    s_add_u32 s70, s70, 4096
    s_mov_b32 m0, s53
    s_add_u32 s53, s53, 4096
    buffer_load_dwordx4 v29, s[12:15], s70 offen lds
    s_add_u32 s70, s70, 4096
    s_mov_b32 m0, s53
    s_add_u32 s53, s53, 4096
    buffer_load_dwordx4 v29, s[12:15], s70 offen lds
    s_add_u32 s70, s70, 4096
    s_mov_b32 m0, s53
    s_add_u32 s53, s53, 4096
    buffer_load_dwordx4 v29, s[12:15], s70 offen lds
    s_add_u32 s70, s70, 4096
    s_mov_b32 m0, s53
    s_add_u32 s53, s53, 4096
    buffer_load_dwordx4 v29, s[12:15], s70 offen lds
    s_add_u32 s70, s70, 4096
    s_mov_b32 m0, 151552
    s_nop 0
    buffer_load_dwordx4 v29, s[16:19], 0 offen lds
    s_lshl_b32 s70, s47, 2
    s_add_u32 s70, s70, s45
    s_cmp_lg_u32 s70, 56
    s_cbranch_scc1 L_ak_nz
    v_lshlrev_b32 v41, 7, v0
    v_mov_b32 v42, 0
    s_lshl_b32 s70, s46, 11
    s_add_u32 s70, s70, 294912
    s_mov_b32 exec_lo, 0xffff
    s_mov_b32 exec_hi, 0
    buffer_store_dword v42, v41, s[28:31], s70 offen sc1
    s_mov_b64 exec, -1
L_ak_nz:
    v_and_b32 v24, 31, v0
    v_bfe_u32 v25, v0, 1, 3
    v_xor_b32 v25, v25, v31
    v_lshlrev_b32 v25, 4, v25
    v_lshl_add_u32 v30, v24, 7, v25
    v_bfe_u32 v28, v0, 2, 2
    v_bfe_u32 v24, v0, 4, 1
    v_and_b32 v25, 3, v0
    v_lshlrev_b32 v25, 3, v25
    v_lshl_add_u32 v27, v24, 5, v25
    v_add_u32 v14, s55, v30
    v_xor_b32 v15, 32, v14
    v_xor_b32 v16, 64, v14
    v_xor_b32 v17, 96, v14
    v_lshl_add_u32 v25, v31, 3, v28
    v_lshl_add_u32 v18, v25, 6, v27
    v_add_u32 v18, s57, v18
    v_add_u32 v19, 0x10000, v14
    v_add_u32 v88, 0x20000, v14
    v_add_u32 v20, 0x10000, v15
    v_add_u32 v89, 0x20000, v15
    v_add_u32 v21, 0x10000, v16
    v_add_u32 v90, 0x20000, v16
    v_add_u32 v22, 0x10000, v17
    v_add_u32 v91, 0x20000, v17
    v_add_u32 v23, 0x10000, v18
    v_add_u32 v92, 0x20000, v18
    v_mov_b32 v24, 163792
    v_mov_b32 v94, 0
    v_mov_b32 v95, 0
    ds_write_b64 v24, v[94:95] offset:0
    ds_write_b64 v24, v[94:95] offset:8
    ds_write_b64 v24, v[94:95] offset:16
    ds_write_b64 v24, v[94:95] offset:24
    ds_write_b64 v24, v[94:95] offset:32
    ds_write_b64 v24, v[94:95] offset:40
    s_lshl_b32 s70, s45, 16
    s_add_u32 s40, s28, s70
    s_addc_u32 s41, s29, 0
    v_add_u32 v23, 0x10000, v18
    s_waitcnt vmcnt(0) lgkmcnt(0)
    s_barrier
    v_mov_b32 v128, 0
    v_mov_b32 v129, 0
    v_mov_b32 v130, 0
    v_mov_b32 v131, 0
    v_mov_b32 v132, 0
    v_mov_b32 v133, 0
    v_mov_b32 v134, 0
    v_mov_b32 v135, 0
    v_mov_b32 v136, 0
    v_mov_b32 v137, 0
    v_mov_b32 v138, 0
    v_mov_b32 v139, 0
    v_mov_b32 v140, 0
    v_mov_b32 v141, 0
    v_mov_b32 v142, 0
    v_mov_b32 v143, 0
    v_mov_b32 v144, 0
    v_mov_b32 v145, 0
    v_mov_b32 v146, 0
    v_mov_b32 v147, 0
    v_mov_b32 v148, 0
    v_mov_b32 v149, 0
    v_mov_b32 v150, 0
    v_mov_b32 v151, 0
    v_mov_b32 v152, 0
    v_mov_b32 v153, 0
    v_mov_b32 v154, 0
    v_mov_b32 v155, 0
    v_mov_b32 v156, 0
    v_mov_b32 v157, 0
    v_mov_b32 v158, 0
    v_mov_b32 v159, 0
    v_mov_b32 v160, 0
    v_mov_b32 v161, 0
    v_mov_b32 v162, 0
    v_mov_b32 v163, 0
    v_mov_b32 v164, 0
    v_mov_b32 v165, 0
    v_mov_b32 v166, 0
    v_mov_b32 v167, 0
    v_mov_b32 v168, 0
    v_mov_b32 v169, 0
    v_mov_b32 v170, 0
    v_mov_b32 v171, 0
    v_mov_b32 v172, 0
    v_mov_b32 v173, 0
    v_mov_b32 v174, 0
    v_mov_b32 v175, 0
    v_mov_b32 v176, 0
    v_mov_b32 v177, 0
    v_mov_b32 v178, 0
    v_mov_b32 v179, 0
    v_mov_b32 v180, 0
    v_mov_b32 v181, 0
    v_mov_b32 v182, 0
    v_mov_b32 v183, 0
    v_mov_b32 v184, 0
    v_mov_b32 v185, 0
    v_mov_b32 v186, 0
    v_mov_b32 v187, 0
    v_mov_b32 v188, 0
    v_mov_b32 v189, 0
    v_mov_b32 v190, 0
    v_mov_b32 v191, 0
    v_mov_b32 v80, 0
    v_mov_b32 v81, 0
    v_mov_b32 v82, 0
    v_mov_b32 v83, 0
    v_mov_b32 v84, 0
    v_mov_b32 v85, 0
    v_mov_b32 v86, 0
    v_mov_b32 v87, 0
    v_mov_b32 v248, 0
    v_mov_b32 v249, 0
    v_mov_b32 v250, 0
    v_mov_b32 v251, 0
    v_mov_b32 v252, 0
    v_mov_b32 v253, 0
    v_mov_b32 v254, 0
    v_mov_b32 v255, 0
    v_and_b32 v94, 31, v0
    v_lshlrev_b32 v94, 2, v94
    s_add_u32 m0, s56, 114688
    s_nop 0
    buffer_load_dwordx4 v13, s[8:11], s54 offen lds
    s_add_u32 s54, s54, 57344
    s_add_u32 m0, s56, 118784
    s_nop 0
    buffer_load_dwordx4 v13, s[8:11], s54 offen lds
    s_add_u32 s54, s54, 57344
    s_add_u32 m0, s56, 152576
    s_nop 0
    buffer_load_dwordx4 v13, s[8:11], s54 offen lds
    s_add_u32 s54, s54, 57344
    s_add_u32 m0, s56, 156672
    s_nop 0
    buffer_load_dwordx4 v13, s[8:11], s54 offen lds
    s_add_u32 s54, s54, 57344
    s_waitcnt vmcnt(0)
    s_barrier
    s_add_u32 m0, s56, 122880
    s_nop 0
    buffer_load_dwordx4 v13, s[8:11], s54 offen lds
    s_add_u32 s54, s54, 57344
    s_add_u32 m0, s56, 126976
    s_nop 0
    buffer_load_dwordx4 v13, s[8:11], s54 offen lds
    s_add_u32 s54, s54, 57344
    s_add_u32 m0, s56, 131072
    s_nop 0
    buffer_load_dwordx4 v13, s[8:11], s54 offen lds
    s_add_u32 s54, s54, 57344
    ds_read_b128 v[48:51], v14 offset:0
    ds_read_b64_tr_b16 v[64:65], v23 offset:49152
    ds_read_b64_tr_b16 v[66:67], v23 offset:49408
    ds_read_b128 v[52:55], v15 offset:0
    ds_read_b64_tr_b16 v[68:69], v23 offset:50176
    ds_read_b64_tr_b16 v[70:71], v23 offset:50432
    ds_read_b128 v[56:59], v16 offset:0
    ds_read_b64_tr_b16 v[72:73], v23 offset:51200
    ds_read_b64_tr_b16 v[74:75], v23 offset:51456
    s_waitcnt lgkmcnt(6)
    v_mfma_f32_32x32x16_bf16 v[32:47], v[64:67], v[48:51], 0
    ds_read_b128 v[60:63], v17 offset:0
    ds_read_b64_tr_b16 v[76:77], v23 offset:52224
    ds_read_b64_tr_b16 v[78:79], v23 offset:52480
    s_waitcnt lgkmcnt(6)
    v_mfma_f32_32x32x16_bf16 v[32:47], v[68:71], v[52:55], v[32:47]
    ds_read_b128 v[48:51], v14 offset:16384
    ds_read_b64_tr_b16 v[64:65], v23 offset:53248
    ds_read_b64_tr_b16 v[66:67], v23 offset:53504
    s_waitcnt lgkmcnt(6)
    v_mfma_f32_32x32x16_bf16 v[32:47], v[72:75], v[56:59], v[32:47]
    ds_read_b128 v[52:55], v15 offset:16384
    ds_read_b64_tr_b16 v[68:69], v23 offset:54272
    ds_read_b64_tr_b16 v[70:71], v23 offset:54528
    s_waitcnt lgkmcnt(6)
    v_mfma_f32_32x32x16_bf16 v[32:47], v[76:79], v[60:63], v[32:47]
    ds_read_b128 v[56:59], v16 offset:16384
    ds_read_b64_tr_b16 v[72:73], v23 offset:55296
    ds_read_b64_tr_b16 v[74:75], v23 offset:55552
    s_waitcnt lgkmcnt(6)
    v_mfma_f32_32x32x16_bf16 v[32:47], v[64:67], v[48:51], v[32:47]
    ds_read_b128 v[60:63], v17 offset:16384
    ds_read_b64_tr_b16 v[76:77], v23 offset:56320
    ds_read_b64_tr_b16 v[78:79], v23 offset:56576
    s_waitcnt lgkmcnt(6)
    v_mfma_f32_32x32x16_bf16 v[32:47], v[68:71], v[52:55], v[32:47]
    ds_read_b128 v[48:51], v14 offset:32768
    ds_read_b64_tr_b16 v[64:65], v92 offset:21504
    ds_read_b64_tr_b16 v[66:67], v92 offset:21760
    s_waitcnt lgkmcnt(6)
    v_mfma_f32_32x32x16_bf16 v[32:47], v[72:75], v[56:59], v[32:47]
    ds_read_b128 v[52:55], v15 offset:32768
    ds_read_b64_tr_b16 v[68:69], v92 offset:22528
    ds_read_b64_tr_b16 v[70:71], v92 offset:22784
    s_waitcnt lgkmcnt(6)
    v_mfma_f32_32x32x16_bf16 v[32:47], v[76:79], v[60:63], v[32:47]
    ds_read_b128 v[56:59], v16 offset:32768
    ds_read_b64_tr_b16 v[72:73], v92 offset:23552
    ds_read_b64_tr_b16 v[74:75], v92 offset:23808
    s_waitcnt lgkmcnt(6)
    v_mfma_f32_32x32x16_bf16 v[32:47], v[64:67], v[48:51], v[32:47]
    ds_read_b128 v[60:63], v17 offset:32768
    ds_read_b64_tr_b16 v[76:77], v92 offset:24576
    ds_read_b64_tr_b16 v[78:79], v92 offset:24832
    s_waitcnt lgkmcnt(6)
    v_mfma_f32_32x32x16_bf16 v[32:47], v[68:71], v[52:55], v[32:47]
    ds_read_b128 v[48:51], v14 offset:49152
    ds_read_b64_tr_b16 v[64:65], v92 offset:25600
    ds_read_b64_tr_b16 v[66:67], v92 offset:25856
    s_waitcnt lgkmcnt(6)
    v_mfma_f32_32x32x16_bf16 v[32:47], v[72:75], v[56:59], v[32:47]
    ds_read_b128 v[52:55], v15 offset:49152
    ds_read_b64_tr_b16 v[68:69], v92 offset:26624
    ds_read_b64_tr_b16 v[70:71], v92 offset:26880
    s_waitcnt lgkmcnt(6)
    v_mfma_f32_32x32x16_bf16 v[32:47], v[76:79], v[60:63], v[32:47]
    ds_read_b128 v[56:59], v16 offset:49152
    ds_read_b64_tr_b16 v[72:73], v92 offset:27648
    ds_read_b64_tr_b16 v[74:75], v92 offset:27904
    s_waitcnt lgkmcnt(6)
    v_mfma_f32_32x32x16_bf16 v[32:47], v[64:67], v[48:51], v[32:47]
    ds_read_b128 v[60:63], v17 offset:49152
    ds_read_b64_tr_b16 v[76:77], v92 offset:28672
    ds_read_b64_tr_b16 v[78:79], v92 offset:28928
    s_waitcnt lgkmcnt(6)
    v_mfma_f32_32x32x16_bf16 v[32:47], v[68:71], v[52:55], v[32:47]
    s_waitcnt vmcnt(0)
    s_barrier
    ds_read_b128 v[48:51], v19 offset:0
    ds_read_b64_tr_b16 v[64:65], v23 offset:57344
    ds_read_b64_tr_b16 v[66:67], v23 offset:57600
    s_waitcnt lgkmcnt(6)
    v_mfma_f32_32x32x16_bf16 v[32:47], v[72:75], v[56:59], v[32:47]
    ds_read_b128 v[52:55], v20 offset:0
    ds_read_b64_tr_b16 v[68:69], v23 offset:58368
    ds_read_b64_tr_b16 v[70:71], v23 offset:58624
    s_waitcnt lgkmcnt(6)
    v_mfma_f32_32x32x16_bf16 v[32:47], v[76:79], v[60:63], v[32:47]
    ds_read_b128 v[56:59], v21 offset:0
    ds_read_b64_tr_b16 v[72:73], v23 offset:59392
    ds_read_b64_tr_b16 v[74:75], v23 offset:59648
    s_waitcnt lgkmcnt(6)
    v_mfma_f32_32x32x16_bf16 v[32:47], v[64:67], v[48:51], v[32:47]
    ds_read_b128 v[60:63], v22 offset:0
    ds_read_b64_tr_b16 v[76:77], v23 offset:60416
    ds_read_b64_tr_b16 v[78:79], v23 offset:60672
    s_waitcnt lgkmcnt(6)
    v_mfma_f32_32x32x16_bf16 v[32:47], v[68:71], v[52:55], v[32:47]
    ds_read_b128 v[48:51], v19 offset:16384
    ds_read_b64_tr_b16 v[64:65], v23 offset:61440
    ds_read_b64_tr_b16 v[66:67], v23 offset:61696
    s_waitcnt lgkmcnt(6)
    v_mfma_f32_32x32x16_bf16 v[32:47], v[72:75], v[56:59], v[32:47]
    ds_read_b128 v[52:55], v20 offset:16384
    ds_read_b64_tr_b16 v[68:69], v23 offset:62464
    ds_read_b64_tr_b16 v[70:71], v23 offset:62720
    s_waitcnt lgkmcnt(6)
    v_mfma_f32_32x32x16_bf16 v[32:47], v[76:79], v[60:63], v[32:47]
    ds_read_b128 v[56:59], v21 offset:16384
    ds_read_b64_tr_b16 v[72:73], v23 offset:63488
    ds_read_b64_tr_b16 v[74:75], v23 offset:63744
    s_waitcnt lgkmcnt(6)
    v_mfma_f32_32x32x16_bf16 v[32:47], v[64:67], v[48:51], v[32:47]
    ds_read_b128 v[60:63], v22 offset:16384
    ds_read_b64_tr_b16 v[76:77], v23 offset:64512
    ds_read_b64_tr_b16 v[78:79], v23 offset:64768
    s_waitcnt lgkmcnt(6)
    v_mfma_f32_32x32x16_bf16 v[32:47], v[68:71], v[52:55], v[32:47]
    ds_read_b128 v[48:51], v19 offset:32768
    ds_read_b64_tr_b16 v[64:65], v92 offset:0
    ds_read_b64_tr_b16 v[66:67], v92 offset:256
    s_waitcnt lgkmcnt(6)
    v_mfma_f32_32x32x16_bf16 v[32:47], v[72:75], v[56:59], v[32:47]
    ds_read_b128 v[52:55], v20 offset:32768
    ds_read_b64_tr_b16 v[68:69], v92 offset:1024
    ds_read_b64_tr_b16 v[70:71], v92 offset:1280
    s_waitcnt lgkmcnt(6)
    v_mfma_f32_32x32x16_bf16 v[32:47], v[76:79], v[60:63], v[32:47]
    ds_read_b128 v[56:59], v21 offset:32768
    ds_read_b64_tr_b16 v[72:73], v92 offset:2048
    ds_read_b64_tr_b16 v[74:75], v92 offset:2304
    s_waitcnt lgkmcnt(6)
    v_mfma_f32_32x32x16_bf16 v[32:47], v[64:67], v[48:51], v[32:47]
    ds_read_b128 v[60:63], v22 offset:32768
    ds_read_b64_tr_b16 v[76:77], v92 offset:3072
    ds_read_b64_tr_b16 v[78:79], v92 offset:3328
    s_waitcnt lgkmcnt(6)
    v_mfma_f32_32x32x16_bf16 v[32:47], v[68:71], v[52:55], v[32:47]
    s_waitcnt lgkmcnt(3)
    v_mfma_f32_32x32x16_bf16 v[32:47], v[72:75], v[56:59], v[32:47]
    s_waitcnt lgkmcnt(0)
    v_mfma_f32_32x32x16_bf16 v[32:47], v[76:79], v[60:63], v[32:47]
    s_mov_b32 s62, 131072
L_ak_poll:
    buffer_load_dword v24, off, s[36:39], 0 offset:128 sc1
    s_waitcnt vmcnt(0)
    v_readfirstlane_b32 s63, v24
    s_sub_u32 s62, s62, 1
    s_cmp_eq_u32 s62, 0
    s_cbranch_scc1 L_ak_poll_x
    s_cmp_lg_u32 s63, 0
    s_cbranch_scc1 L_ak_poll_x
    s_sleep 4
    s_branch L_ak_poll
L_ak_poll_x:
    s_lshl_b32 s70, s69, 2
    s_add_u32 s70, s70, s45
    s_lshl_b32 s70, s70, 11
    v_lshlrev_b32 v24, 7, v0
    s_mov_b32 exec_lo, 0xffff
    s_mov_b32 exec_hi, 0
    buffer_load_dword v95, v24, s[28:31], s70 offen sc1
    s_mov_b64 exec, -1
    s_lshl_b32 s70, s46, 2
    s_add_u32 s70, s70, s45
    s_lshl_b32 s70, s70, 7
    s_add_u32 s70, s70, 262144
    buffer_load_dword v93, v94, s[28:31], s70 offen sc1
    v_add_u32 v30, 4096, v29
    global_load_dwordx4 v[192:195], v30, s[40:41] offset:-4096 sc1
    global_load_dwordx4 v[196:199], v30, s[40:41] offset:-3072 sc1
    global_load_dwordx4 v[224:227], v30, s[40:41] offset:-2048 sc1
    global_load_dwordx4 v[228:231], v30, s[40:41] offset:-1024 sc1
    global_load_dwordx4 v[200:203], v30, s[40:41] offset:0 sc1
    global_load_dwordx4 v[204:207], v30, s[40:41] offset:1024 sc1
    global_load_dwordx4 v[232:235], v30, s[40:41] offset:2048 sc1
    global_load_dwordx4 v[236:239], v30, s[40:41] offset:3072 sc1
    v_add_u32 v30, 8192, v30
    global_load_dwordx4 v[208:211], v30, s[40:41] offset:-4096 sc1
    global_load_dwordx4 v[212:215], v30, s[40:41] offset:-3072 sc1
    global_load_dwordx4 v[240:243], v30, s[40:41] offset:-2048 sc1
    global_load_dwordx4 v[244:247], v30, s[40:41] offset:-1024 sc1
    s_mov_b32 s58, 139264
L_attn:
    s_setprio 3
    s_mov_b32 s64, 1049335798
    s_nop 0
    v_cmp_eq_u32 vcc, 0, v31
    s_lshl_b32 s66, s45, 11
    s_add_u32 s66, s66, s58
    v_add_u32 v24, s66, v29
    v_mov_b32 v25, 163792
    v_mov_b32 v26, 1
    s_nop 2
    v_mul_f32 v32, s64, v32
    v_mul_f32 v33, s64, v33
    v_mul_f32 v34, s64, v34
    v_mul_f32 v35, s64, v35
    v_mul_f32 v36, s64, v36
    v_mul_f32 v37, s64, v37
    v_mul_f32 v38, s64, v38
    v_mul_f32 v39, s64, v39
    v_mul_f32 v40, s64, v40
    v_mul_f32 v41, s64, v41
    v_mul_f32 v42, s64, v42
    v_mul_f32 v43, s64, v43
    v_mul_f32 v44, s64, v44
    v_mul_f32 v45, s64, v45
    v_mul_f32 v46, s64, v46
    v_mul_f32 v47, s64, v47
    v_cvt_pk_bf16_f32 v120, v32, v33
    v_cvt_pk_bf16_f32 v121, v34, v35
    v_cvt_pk_bf16_f32 v122, v36, v37
    v_cvt_pk_bf16_f32 v123, v38, v39
    v_cvt_pk_bf16_f32 v124, v40, v41
    v_cvt_pk_bf16_f32 v125, v42, v43
    v_cvt_pk_bf16_f32 v126, v44, v45
    v_cvt_pk_bf16_f32 v127, v46, v47
    v_cndmask_b32 v126, 0, v126, vcc
    v_cndmask_b32 v127, 0, v127, vcc
    ds_write_b128 v24, v[120:123]
    s_waitcnt vmcnt(10)
    v_mfma_f32_32x32x16_bf16 v[48:63], v[192:195], v[120:123], 0
    v_mfma_f32_32x32x16_bf16 v[48:63], v[196:199], v[124:127], v[48:63]
    s_add_u32 s65, s45, 1
    s_and_b32 s65, s65, 3
    s_lshl_b32 s65, s65, 11
    s_add_u32 s65, s65, s58
    v_add_u32 v1, s65, v29
    s_add_u32 s65, s45, 2
    s_and_b32 s65, s65, 3
    s_lshl_b32 s65, s65, 11
    s_add_u32 s65, s65, s58
    v_add_u32 v2, s65, v29
    s_add_u32 s65, s45, 3
    s_and_b32 s65, s65, 3
    s_lshl_b32 s65, s65, 11
    s_add_u32 s65, s65, s58
    v_add_u32 v3, s65, v29
    v_max3_f32 v4, v48, v49, v50
    v_max3_f32 v5, v51, v52, v53
    v_max3_f32 v4, v4, v54, v55
    v_max3_f32 v5, v5, v56, v57
    v_max3_f32 v4, v4, v58, v59
    v_max3_f32 v5, v5, v60, v61
    v_max3_f32 v4, v4, v62, v63
    v_max_f32 v4, v4, v5
    v_mov_b32 v5, v4
    s_nop 1
    v_permlane32_swap_b32 v4, v5
    s_nop 0
    v_max_f32 v4, v4, v5
    v_cvt_pk_bf16_f32 v4, -v4, 0
    v_cndmask_b32 v126, v4, v126, vcc
    ds_write_b128 v24, v[124:127] offset:1024
    s_mov_b64 exec, 1
    ds_add_u32 v25, v26 offset:4
    s_mov_b64 exec, -1
    s_mov_b32 s62, 1048576
L_qspin:
    ds_read_b32 v5, v25 offset:4
    s_waitcnt lgkmcnt(0)
    v_readfirstlane_b32 s63, v5
    s_sub_u32 s62, s62, 1
    s_cmp_eq_u32 s62, 0
    s_cbranch_scc1 L_qspin_x
    s_cmp_lt_u32 s63, 4
    s_cbranch_scc1 L_qspin
L_qspin_x:
    ds_read_b128 v[96:99], v1
    ds_read_b128 v[100:103], v1 offset:1024
    ds_read_b128 v[104:107], v2
    ds_read_b128 v[108:111], v2 offset:1024
    ds_read_b128 v[112:115], v3
    ds_read_b128 v[116:119], v3 offset:1024
    s_mov_b64 exec, 1
    ds_add_u32 v25, v26 offset:28
    s_mov_b64 exec, -1
    s_waitcnt lgkmcnt(5)
    v_mfma_f32_32x32x16_bf16 v[48:63], v[192:195], v[96:99], 0
    v_mfma_f32_32x32x16_bf16 v[48:63], v[196:199], v[100:103], v[48:63]
    s_add_u32 s65, s45, 1
    s_and_b32 s65, s65, 3
    s_mul_i32 s65, s65, 12288
    s_add_u32 s65, s65, 114688
    v_add_u32 v1, s65, v29
    s_add_u32 s65, s45, 2
    s_and_b32 s65, s65, 3
    s_mul_i32 s65, s65, 12288
    s_add_u32 s65, s65, 118784
    v_add_u32 v2, s65, v29
    s_add_u32 s65, s45, 3
    s_and_b32 s65, s65, 3
    s_mul_i32 s65, s65, 12288
    s_add_u32 s65, s65, 122880
    v_add_u32 v3, s65, v29
    s_mul_i32 s65, s45, 12288
    s_add_u32 s65, s65, 114688
    v_add_u32 v4, s65, v29
    s_lshl_b32 s65, s46, 2
    s_add_u32 s65, s65, s45
    s_lshl_b32 s65, s65, 4
    s_add_u32 s65, s65, s50
    s_lshl_b32 s65, s65, 11
    s_add_u32 s65, s65, 524288
    v_mov_b32 v7, 1904214016
    v_mov_b32 v8, 562036736
    v_mov_b32 v9, 0x7f800000
    s_waitcnt vmcnt(8) lgkmcnt(0)
    s_mov_b32 s59, 3
    v_mov_b32 v6, 0x100
    s_setprio 1
.p2align 6
L_aloop:
    v_mfma_f32_32x32x16_bf16 v[64:79], v[192:195], v[104:107], 0
    v_exp_f32 v48, v48
    v_exp_f32 v49, v49
    v_exp_f32 v50, v50
    v_mfma_f32_32x32x16_bf16 v[64:79], v[196:199], v[108:111], v[64:79]
    v_exp_f32 v51, v51
    v_exp_f32 v52, v52
    v_exp_f32 v53, v53
    v_mfma_f32_32x32x16_bf16 v[176:191], v[248:251], v[80:83], v[176:191]
    v_exp_f32 v54, v54
    v_exp_f32 v55, v55
    v_exp_f32 v56, v56
    v_mfma_f32_32x32x16_bf16 v[176:191], v[252:255], v[84:87], v[176:191]
    v_exp_f32 v57, v57
    v_exp_f32 v58, v58
    v_exp_f32 v59, v59
    v_exp_f32 v60, v60
    v_exp_f32 v61, v61
    v_exp_f32 v62, v62
    v_exp_f32 v63, v63
    v_cvt_pk_bf16_f32 v80, v48, v49
    v_cvt_pk_bf16_f32 v81, v50, v51
    v_cvt_pk_bf16_f32 v82, v52, v53
    v_cvt_pk_bf16_f32 v83, v54, v55
    v_cvt_pk_bf16_f32 v84, v56, v57
    v_cvt_pk_bf16_f32 v85, v58, v59
    v_cvt_pk_bf16_f32 v86, v60, v61
    v_cvt_pk_bf16_f32 v87, v62, v63
    v_mfma_f32_32x32x16_bf16 v[48:63], v[192:195], v[112:115], 0
    v_exp_f32 v64, v64
    v_exp_f32 v65, v65
    v_exp_f32 v66, v66
    v_mfma_f32_32x32x16_bf16 v[48:63], v[196:199], v[116:119], v[48:63]
    v_exp_f32 v67, v67
    v_exp_f32 v68, v68
    v_exp_f32 v69, v69
    v_mfma_f32_32x32x16_bf16 v[128:143], v[224:227], v[80:83], v[128:143]
    v_exp_f32 v70, v70
    v_exp_f32 v71, v71
    v_exp_f32 v72, v72
    v_mfma_f32_32x32x16_bf16 v[128:143], v[228:231], v[84:87], v[128:143]
    v_exp_f32 v73, v73
    v_exp_f32 v74, v74
    v_exp_f32 v75, v75
    global_load_dwordx4 v[216:219], v30, s[40:41] offset:0 sc1
    global_load_dwordx4 v[220:223], v30, s[40:41] offset:1024 sc1
    global_load_dwordx4 v[248:251], v30, s[40:41] offset:2048 sc1
    global_load_dwordx4 v[252:255], v30, s[40:41] offset:3072 sc1
    v_add_u32 v30, 8192, v30
    v_exp_f32 v76, v76
    v_exp_f32 v77, v77
    v_exp_f32 v78, v78
    v_exp_f32 v79, v79
    v_cvt_pk_bf16_f32 v80, v64, v65
    v_cvt_pk_bf16_f32 v81, v66, v67
    v_cvt_pk_bf16_f32 v82, v68, v69
    v_cvt_pk_bf16_f32 v83, v70, v71
    v_cvt_pk_bf16_f32 v84, v72, v73
    v_cvt_pk_bf16_f32 v85, v74, v75
    v_cvt_pk_bf16_f32 v86, v76, v77
    v_cvt_pk_bf16_f32 v87, v78, v79
    v_mfma_f32_32x32x16_bf16 v[64:79], v[192:195], v[120:123], 0
    v_exp_f32 v48, v48
    v_exp_f32 v49, v49
    v_exp_f32 v50, v50
    v_mfma_f32_32x32x16_bf16 v[64:79], v[196:199], v[124:127], v[64:79]
    v_exp_f32 v51, v51
    v_exp_f32 v52, v52
    v_exp_f32 v53, v53
    v_mfma_f32_32x32x16_bf16 v[144:159], v[224:227], v[80:83], v[144:159]
    v_exp_f32 v54, v54
    v_exp_f32 v55, v55
    v_exp_f32 v56, v56
    v_mfma_f32_32x32x16_bf16 v[144:159], v[228:231], v[84:87], v[144:159]
    v_exp_f32 v57, v57
    v_exp_f32 v58, v58
    v_exp_f32 v59, v59
    v_exp_f32 v60, v60
    v_exp_f32 v61, v61
    v_exp_f32 v62, v62
    s_waitcnt vmcnt(8)
    v_exp_f32 v63, v63
    v_cvt_pk_bf16_f32 v80, v48, v49
    v_cvt_pk_bf16_f32 v81, v50, v51
    v_cvt_pk_bf16_f32 v82, v52, v53
    v_cvt_pk_bf16_f32 v83, v54, v55
    v_cvt_pk_bf16_f32 v84, v56, v57
    v_cvt_pk_bf16_f32 v85, v58, v59
    v_cvt_pk_bf16_f32 v86, v60, v61
    v_cvt_pk_bf16_f32 v87, v62, v63
    v_mfma_f32_32x32x16_bf16 v[48:63], v[200:203], v[96:99], 0
    v_exp_f32 v64, v64
    v_exp_f32 v65, v65
    v_exp_f32 v66, v66
    v_mfma_f32_32x32x16_bf16 v[48:63], v[204:207], v[100:103], v[48:63]
    v_exp_f32 v67, v67
    v_exp_f32 v68, v68
    v_exp_f32 v69, v69
    v_mfma_f32_32x32x16_bf16 v[160:175], v[224:227], v[80:83], v[160:175]
    v_exp_f32 v70, v70
    v_exp_f32 v71, v71
    v_exp_f32 v72, v72
    v_mfma_f32_32x32x16_bf16 v[160:175], v[228:231], v[84:87], v[160:175]
    v_exp_f32 v73, v73
    v_exp_f32 v74, v74
    v_exp_f32 v75, v75
    v_exp_f32 v76, v76
    v_exp_f32 v77, v77
    v_exp_f32 v78, v78
    v_exp_f32 v79, v79
    v_cvt_pk_bf16_f32 v80, v64, v65
    v_cvt_pk_bf16_f32 v81, v66, v67
    v_cvt_pk_bf16_f32 v82, v68, v69
    v_cvt_pk_bf16_f32 v83, v70, v71
    v_cvt_pk_bf16_f32 v84, v72, v73
    v_cvt_pk_bf16_f32 v85, v74, v75
    v_cvt_pk_bf16_f32 v86, v76, v77
    v_cvt_pk_bf16_f32 v87, v78, v79
    v_mfma_f32_32x32x16_bf16 v[64:79], v[200:203], v[104:107], 0
    v_exp_f32 v48, v48
    v_exp_f32 v49, v49
    v_exp_f32 v50, v50
    v_mfma_f32_32x32x16_bf16 v[64:79], v[204:207], v[108:111], v[64:79]
    v_exp_f32 v51, v51
    v_exp_f32 v52, v52
    v_exp_f32 v53, v53
    v_mfma_f32_32x32x16_bf16 v[176:191], v[224:227], v[80:83], v[176:191]
    v_exp_f32 v54, v54
    v_exp_f32 v55, v55
    v_exp_f32 v56, v56
    v_mfma_f32_32x32x16_bf16 v[176:191], v[228:231], v[84:87], v[176:191]
    v_exp_f32 v57, v57
    v_exp_f32 v58, v58
    v_exp_f32 v59, v59
    v_exp_f32 v60, v60
    v_exp_f32 v61, v61
    v_exp_f32 v62, v62
    v_exp_f32 v63, v63
    v_cvt_pk_bf16_f32 v80, v48, v49
    v_cvt_pk_bf16_f32 v81, v50, v51
    v_cvt_pk_bf16_f32 v82, v52, v53
    v_cvt_pk_bf16_f32 v83, v54, v55
    v_cvt_pk_bf16_f32 v84, v56, v57
    v_cvt_pk_bf16_f32 v85, v58, v59
    v_cvt_pk_bf16_f32 v86, v60, v61
    v_cvt_pk_bf16_f32 v87, v62, v63
    v_mfma_f32_32x32x16_bf16 v[48:63], v[200:203], v[112:115], 0
    v_exp_f32 v64, v64
    v_exp_f32 v65, v65
    v_exp_f32 v66, v66
    v_mfma_f32_32x32x16_bf16 v[48:63], v[204:207], v[116:119], v[48:63]
    v_exp_f32 v67, v67
    v_exp_f32 v68, v68
    v_exp_f32 v69, v69
    v_mfma_f32_32x32x16_bf16 v[128:143], v[232:235], v[80:83], v[128:143]
    v_exp_f32 v70, v70
    v_exp_f32 v71, v71
    v_exp_f32 v72, v72
    v_mfma_f32_32x32x16_bf16 v[128:143], v[236:239], v[84:87], v[128:143]
    v_exp_f32 v73, v73
    v_exp_f32 v74, v74
    v_exp_f32 v75, v75
    global_load_dwordx4 v[192:195], v30, s[40:41] offset:-4096 sc1
    global_load_dwordx4 v[196:199], v30, s[40:41] offset:-3072 sc1
    global_load_dwordx4 v[224:227], v30, s[40:41] offset:-2048 sc1
    global_load_dwordx4 v[228:231], v30, s[40:41] offset:-1024 sc1
    v_exp_f32 v76, v76
    v_exp_f32 v77, v77
    v_exp_f32 v78, v78
    v_exp_f32 v79, v79
    v_cvt_pk_bf16_f32 v80, v64, v65
    v_cvt_pk_bf16_f32 v81, v66, v67
    v_cvt_pk_bf16_f32 v82, v68, v69
    v_cvt_pk_bf16_f32 v83, v70, v71
    v_cvt_pk_bf16_f32 v84, v72, v73
    v_cvt_pk_bf16_f32 v85, v74, v75
    v_cvt_pk_bf16_f32 v86, v76, v77
    v_cvt_pk_bf16_f32 v87, v78, v79
    v_mfma_f32_32x32x16_bf16 v[64:79], v[200:203], v[120:123], 0
    v_exp_f32 v48, v48
    v_exp_f32 v49, v49
    v_exp_f32 v50, v50
    v_mfma_f32_32x32x16_bf16 v[64:79], v[204:207], v[124:127], v[64:79]
    v_exp_f32 v51, v51
    v_exp_f32 v52, v52
    v_exp_f32 v53, v53
    v_mfma_f32_32x32x16_bf16 v[144:159], v[232:235], v[80:83], v[144:159]
    v_exp_f32 v54, v54
    v_exp_f32 v55, v55
    v_exp_f32 v56, v56
    v_mfma_f32_32x32x16_bf16 v[144:159], v[236:239], v[84:87], v[144:159]
    v_exp_f32 v57, v57
    v_exp_f32 v58, v58
    v_exp_f32 v59, v59
    v_exp_f32 v60, v60
    v_exp_f32 v61, v61
    v_exp_f32 v62, v62
    s_waitcnt vmcnt(8)
    v_exp_f32 v63, v63
    v_cvt_pk_bf16_f32 v80, v48, v49
    v_cvt_pk_bf16_f32 v81, v50, v51
    v_cvt_pk_bf16_f32 v82, v52, v53
    v_cvt_pk_bf16_f32 v83, v54, v55
    v_cvt_pk_bf16_f32 v84, v56, v57
    v_cvt_pk_bf16_f32 v85, v58, v59
    v_cvt_pk_bf16_f32 v86, v60, v61
    v_cvt_pk_bf16_f32 v87, v62, v63
    v_mfma_f32_32x32x16_bf16 v[48:63], v[208:211], v[96:99], 0
    v_exp_f32 v64, v64
    v_exp_f32 v65, v65
    v_exp_f32 v66, v66
    v_mfma_f32_32x32x16_bf16 v[48:63], v[212:215], v[100:103], v[48:63]
    v_exp_f32 v67, v67
    v_exp_f32 v68, v68
    v_exp_f32 v69, v69
    v_mfma_f32_32x32x16_bf16 v[160:175], v[232:235], v[80:83], v[160:175]
    v_exp_f32 v70, v70
    v_exp_f32 v71, v71
    v_exp_f32 v72, v72
    v_mfma_f32_32x32x16_bf16 v[160:175], v[236:239], v[84:87], v[160:175]
    v_exp_f32 v73, v73
    v_exp_f32 v74, v74
    v_exp_f32 v75, v75
    v_exp_f32 v76, v76
    v_exp_f32 v77, v77
    v_exp_f32 v78, v78
    v_exp_f32 v79, v79
    v_cvt_pk_bf16_f32 v80, v64, v65
    v_cvt_pk_bf16_f32 v81, v66, v67
    v_cvt_pk_bf16_f32 v82, v68, v69
    v_cvt_pk_bf16_f32 v83, v70, v71
    v_cvt_pk_bf16_f32 v84, v72, v73
    v_cvt_pk_bf16_f32 v85, v74, v75
    v_cvt_pk_bf16_f32 v86, v76, v77
    v_cvt_pk_bf16_f32 v87, v78, v79
    v_mfma_f32_32x32x16_bf16 v[64:79], v[208:211], v[104:107], 0
    v_exp_f32 v48, v48
    v_exp_f32 v49, v49
    v_exp_f32 v50, v50
    v_mfma_f32_32x32x16_bf16 v[64:79], v[212:215], v[108:111], v[64:79]
    v_exp_f32 v51, v51
    v_exp_f32 v52, v52
    v_exp_f32 v53, v53
    v_mfma_f32_32x32x16_bf16 v[176:191], v[232:235], v[80:83], v[176:191]
    v_exp_f32 v54, v54
    v_exp_f32 v55, v55
    v_exp_f32 v56, v56
    v_mfma_f32_32x32x16_bf16 v[176:191], v[236:239], v[84:87], v[176:191]
    v_exp_f32 v57, v57
    v_exp_f32 v58, v58
    v_exp_f32 v59, v59
    v_exp_f32 v60, v60
    v_exp_f32 v61, v61
    v_exp_f32 v62, v62
    v_exp_f32 v63, v63
    v_cvt_pk_bf16_f32 v80, v48, v49
    v_cvt_pk_bf16_f32 v81, v50, v51
    v_cvt_pk_bf16_f32 v82, v52, v53
    v_cvt_pk_bf16_f32 v83, v54, v55
    v_cvt_pk_bf16_f32 v84, v56, v57
    v_cvt_pk_bf16_f32 v85, v58, v59
    v_cvt_pk_bf16_f32 v86, v60, v61
    v_cvt_pk_bf16_f32 v87, v62, v63
    v_mfma_f32_32x32x16_bf16 v[48:63], v[208:211], v[112:115], 0
    v_exp_f32 v64, v64
    v_exp_f32 v65, v65
    v_exp_f32 v66, v66
    v_mfma_f32_32x32x16_bf16 v[48:63], v[212:215], v[116:119], v[48:63]
    v_exp_f32 v67, v67
    v_exp_f32 v68, v68
    v_exp_f32 v69, v69
    v_mfma_f32_32x32x16_bf16 v[128:143], v[240:243], v[80:83], v[128:143]
    v_exp_f32 v70, v70
    v_exp_f32 v71, v71
    v_exp_f32 v72, v72
    v_mfma_f32_32x32x16_bf16 v[128:143], v[244:247], v[84:87], v[128:143]
    v_exp_f32 v73, v73
    v_exp_f32 v74, v74
    v_exp_f32 v75, v75
    global_load_dwordx4 v[200:203], v30, s[40:41] offset:0 sc1
    global_load_dwordx4 v[204:207], v30, s[40:41] offset:1024 sc1
    global_load_dwordx4 v[232:235], v30, s[40:41] offset:2048 sc1
    global_load_dwordx4 v[236:239], v30, s[40:41] offset:3072 sc1
    v_add_u32 v30, 8192, v30
    v_exp_f32 v76, v76
    v_exp_f32 v77, v77
    v_exp_f32 v78, v78
    v_exp_f32 v79, v79
    v_cvt_pk_bf16_f32 v80, v64, v65
    v_cvt_pk_bf16_f32 v81, v66, v67
    v_cvt_pk_bf16_f32 v82, v68, v69
    v_cvt_pk_bf16_f32 v83, v70, v71
    v_cvt_pk_bf16_f32 v84, v72, v73
    v_cvt_pk_bf16_f32 v85, v74, v75
    v_cvt_pk_bf16_f32 v86, v76, v77
    v_cvt_pk_bf16_f32 v87, v78, v79
    v_mfma_f32_32x32x16_bf16 v[64:79], v[208:211], v[120:123], 0
    v_exp_f32 v48, v48
    v_exp_f32 v49, v49
    v_exp_f32 v50, v50
    v_mfma_f32_32x32x16_bf16 v[64:79], v[212:215], v[124:127], v[64:79]
    v_exp_f32 v51, v51
    v_exp_f32 v52, v52
    v_exp_f32 v53, v53
    v_mfma_f32_32x32x16_bf16 v[144:159], v[240:243], v[80:83], v[144:159]
    v_exp_f32 v54, v54
    v_exp_f32 v55, v55
    v_exp_f32 v56, v56
    v_mfma_f32_32x32x16_bf16 v[144:159], v[244:247], v[84:87], v[144:159]
    v_exp_f32 v57, v57
    v_exp_f32 v58, v58
    v_exp_f32 v59, v59
    v_exp_f32 v60, v60
    v_exp_f32 v61, v61
    v_exp_f32 v62, v62
    s_waitcnt vmcnt(8)
    v_exp_f32 v63, v63
    v_cvt_pk_bf16_f32 v80, v48, v49
    v_cvt_pk_bf16_f32 v81, v50, v51
    v_cvt_pk_bf16_f32 v82, v52, v53
    v_cvt_pk_bf16_f32 v83, v54, v55
    v_cvt_pk_bf16_f32 v84, v56, v57
    v_cvt_pk_bf16_f32 v85, v58, v59
    v_cvt_pk_bf16_f32 v86, v60, v61
    v_cvt_pk_bf16_f32 v87, v62, v63
    v_mfma_f32_32x32x16_bf16 v[48:63], v[216:219], v[96:99], 0
    v_exp_f32 v64, v64
    v_exp_f32 v65, v65
    v_exp_f32 v66, v66
    v_mfma_f32_32x32x16_bf16 v[48:63], v[220:223], v[100:103], v[48:63]
    v_exp_f32 v67, v67
    v_exp_f32 v68, v68
    v_exp_f32 v69, v69
    v_mfma_f32_32x32x16_bf16 v[160:175], v[240:243], v[80:83], v[160:175]
    v_exp_f32 v70, v70
    v_exp_f32 v71, v71
    v_exp_f32 v72, v72
    v_mfma_f32_32x32x16_bf16 v[160:175], v[244:247], v[84:87], v[160:175]
    v_exp_f32 v73, v73
    v_exp_f32 v74, v74
    v_exp_f32 v75, v75
    v_exp_f32 v76, v76
    v_exp_f32 v77, v77
    v_exp_f32 v78, v78
    v_exp_f32 v79, v79
    v_cvt_pk_bf16_f32 v80, v64, v65
    v_cvt_pk_bf16_f32 v81, v66, v67
    v_cvt_pk_bf16_f32 v82, v68, v69
    v_cvt_pk_bf16_f32 v83, v70, v71
    v_cvt_pk_bf16_f32 v84, v72, v73
    v_cvt_pk_bf16_f32 v85, v74, v75
    v_cvt_pk_bf16_f32 v86, v76, v77
    v_cvt_pk_bf16_f32 v87, v78, v79
    v_mfma_f32_32x32x16_bf16 v[64:79], v[216:219], v[104:107], 0
    v_exp_f32 v48, v48
    v_exp_f32 v49, v49
    v_exp_f32 v50, v50
    v_mfma_f32_32x32x16_bf16 v[64:79], v[220:223], v[108:111], v[64:79]
    v_exp_f32 v51, v51
    v_exp_f32 v52, v52
    v_exp_f32 v53, v53
    v_mfma_f32_32x32x16_bf16 v[176:191], v[240:243], v[80:83], v[176:191]
    v_exp_f32 v54, v54
    v_exp_f32 v55, v55
    v_exp_f32 v56, v56
    v_mfma_f32_32x32x16_bf16 v[176:191], v[244:247], v[84:87], v[176:191]
    v_exp_f32 v57, v57
    v_exp_f32 v58, v58
    v_exp_f32 v59, v59
    v_exp_f32 v60, v60
    v_exp_f32 v61, v61
    v_exp_f32 v62, v62
    v_exp_f32 v63, v63
    v_cvt_pk_bf16_f32 v80, v48, v49
    v_cvt_pk_bf16_f32 v81, v50, v51
    v_cvt_pk_bf16_f32 v82, v52, v53
    v_cvt_pk_bf16_f32 v83, v54, v55
    v_cvt_pk_bf16_f32 v84, v56, v57
    v_cvt_pk_bf16_f32 v85, v58, v59
    v_cvt_pk_bf16_f32 v86, v60, v61
    v_cvt_pk_bf16_f32 v87, v62, v63
    v_mfma_f32_32x32x16_bf16 v[48:63], v[216:219], v[112:115], 0
    v_exp_f32 v64, v64
    v_exp_f32 v65, v65
    v_exp_f32 v66, v66
    v_mfma_f32_32x32x16_bf16 v[48:63], v[220:223], v[116:119], v[48:63]
    v_exp_f32 v67, v67
    v_exp_f32 v68, v68
    v_exp_f32 v69, v69
    v_mfma_f32_32x32x16_bf16 v[128:143], v[248:251], v[80:83], v[128:143]
    v_exp_f32 v70, v70
    v_exp_f32 v71, v71
    v_exp_f32 v72, v72
    v_mfma_f32_32x32x16_bf16 v[128:143], v[252:255], v[84:87], v[128:143]
    v_exp_f32 v73, v73
    v_exp_f32 v74, v74
    v_exp_f32 v75, v75
    global_load_dwordx4 v[208:211], v30, s[40:41] offset:-4096 sc1
    global_load_dwordx4 v[212:215], v30, s[40:41] offset:-3072 sc1
    global_load_dwordx4 v[240:243], v30, s[40:41] offset:-2048 sc1
    global_load_dwordx4 v[244:247], v30, s[40:41] offset:-1024 sc1
    v_exp_f32 v76, v76
    v_exp_f32 v77, v77
    v_exp_f32 v78, v78
    v_exp_f32 v79, v79
    v_cvt_pk_bf16_f32 v80, v64, v65
    v_cvt_pk_bf16_f32 v81, v66, v67
    v_cvt_pk_bf16_f32 v82, v68, v69
    v_cvt_pk_bf16_f32 v83, v70, v71
    v_cvt_pk_bf16_f32 v84, v72, v73
    v_cvt_pk_bf16_f32 v85, v74, v75
    v_cvt_pk_bf16_f32 v86, v76, v77
    v_cvt_pk_bf16_f32 v87, v78, v79
    v_mfma_f32_32x32x16_bf16 v[64:79], v[216:219], v[120:123], 0
    v_exp_f32 v48, v48
    v_exp_f32 v49, v49
    v_exp_f32 v50, v50
    v_mfma_f32_32x32x16_bf16 v[64:79], v[220:223], v[124:127], v[64:79]
    v_exp_f32 v51, v51
    v_exp_f32 v52, v52
    v_exp_f32 v53, v53
    v_mfma_f32_32x32x16_bf16 v[144:159], v[248:251], v[80:83], v[144:159]
    v_exp_f32 v54, v54
    v_exp_f32 v55, v55
    v_exp_f32 v56, v56
    v_mfma_f32_32x32x16_bf16 v[144:159], v[252:255], v[84:87], v[144:159]
    v_exp_f32 v57, v57
    v_exp_f32 v58, v58
    v_exp_f32 v59, v59
    v_exp_f32 v60, v60
    v_exp_f32 v61, v61
    v_exp_f32 v62, v62
    s_waitcnt vmcnt(8)
    v_exp_f32 v63, v63
    v_cvt_pk_bf16_f32 v80, v48, v49
    v_cvt_pk_bf16_f32 v81, v50, v51
    v_cvt_pk_bf16_f32 v82, v52, v53
    v_cvt_pk_bf16_f32 v83, v54, v55
    v_cvt_pk_bf16_f32 v84, v56, v57
    v_cvt_pk_bf16_f32 v85, v58, v59
    v_cvt_pk_bf16_f32 v86, v60, v61
    v_cvt_pk_bf16_f32 v87, v62, v63
    v_mfma_f32_32x32x16_bf16 v[48:63], v[192:195], v[96:99], 0
    v_exp_f32 v64, v64
    v_exp_f32 v65, v65
    v_exp_f32 v66, v66
    v_mfma_f32_32x32x16_bf16 v[48:63], v[196:199], v[100:103], v[48:63]
    v_exp_f32 v67, v67
    v_exp_f32 v68, v68
    v_exp_f32 v69, v69
    v_mfma_f32_32x32x16_bf16 v[160:175], v[248:251], v[80:83], v[160:175]
    v_exp_f32 v70, v70
    v_exp_f32 v71, v71
    v_exp_f32 v72, v72
    v_mfma_f32_32x32x16_bf16 v[160:175], v[252:255], v[84:87], v[160:175]
    v_exp_f32 v73, v73
    v_exp_f32 v74, v74
    v_exp_f32 v75, v75
    s_sub_u32 s59, s59, 1
    v_exp_f32 v76, v76
    v_exp_f32 v77, v77
    v_exp_f32 v78, v78
    v_exp_f32 v79, v79
    v_cvt_pk_bf16_f32 v80, v64, v65
    v_cvt_pk_bf16_f32 v81, v66, v67
    v_cvt_pk_bf16_f32 v82, v68, v69
    v_cvt_pk_bf16_f32 v83, v70, v71
    v_cvt_pk_bf16_f32 v84, v72, v73
    v_cvt_pk_bf16_f32 v85, v74, v75
    v_cvt_pk_bf16_f32 v86, v76, v77
    v_cvt_pk_bf16_f32 v87, v78, v79
    s_cmp_lg_u32 s59, 0
    s_cbranch_scc1 L_aloop
    v_mfma_f32_32x32x16_bf16 v[64:79], v[192:195], v[104:107], 0
    v_exp_f32 v48, v48
    v_exp_f32 v49, v49
    v_exp_f32 v50, v50
    v_mfma_f32_32x32x16_bf16 v[64:79], v[196:199], v[108:111], v[64:79]
    v_exp_f32 v51, v51
    v_exp_f32 v52, v52
    v_exp_f32 v53, v53
    v_mfma_f32_32x32x16_bf16 v[176:191], v[248:251], v[80:83], v[176:191]
    v_exp_f32 v54, v54
    v_exp_f32 v55, v55
    v_exp_f32 v56, v56
    v_mfma_f32_32x32x16_bf16 v[176:191], v[252:255], v[84:87], v[176:191]
    v_exp_f32 v57, v57
    v_exp_f32 v58, v58
    v_exp_f32 v59, v59
    global_load_dwordx4 v[216:219], v30, s[40:41] offset:0 sc1
    global_load_dwordx4 v[220:223], v30, s[40:41] offset:1024 sc1
    global_load_dwordx4 v[248:251], v30, s[40:41] offset:2048 sc1
    global_load_dwordx4 v[252:255], v30, s[40:41] offset:3072 sc1
    v_exp_f32 v60, v60
    v_exp_f32 v61, v61
    v_exp_f32 v62, v62
    v_exp_f32 v63, v63
    v_cvt_pk_bf16_f32 v80, v48, v49
    v_cvt_pk_bf16_f32 v81, v50, v51
    v_cvt_pk_bf16_f32 v82, v52, v53
    v_cvt_pk_bf16_f32 v83, v54, v55
    v_cvt_pk_bf16_f32 v84, v56, v57
    v_cvt_pk_bf16_f32 v85, v58, v59
    v_cvt_pk_bf16_f32 v86, v60, v61
    v_cvt_pk_bf16_f32 v87, v62, v63
    v_mfma_f32_32x32x16_bf16 v[48:63], v[192:195], v[112:115], 0
    v_exp_f32 v64, v64
    v_exp_f32 v65, v65
    v_exp_f32 v66, v66
    v_mfma_f32_32x32x16_bf16 v[48:63], v[196:199], v[116:119], v[48:63]
    v_exp_f32 v67, v67
    v_exp_f32 v68, v68
    v_exp_f32 v69, v69
    v_mfma_f32_32x32x16_bf16 v[128:143], v[224:227], v[80:83], v[128:143]
    v_exp_f32 v70, v70
    v_exp_f32 v71, v71
    v_exp_f32 v72, v72
    v_mfma_f32_32x32x16_bf16 v[128:143], v[228:231], v[84:87], v[128:143]
    v_exp_f32 v73, v73
    v_exp_f32 v74, v74
    v_exp_f32 v75, v75
    v_exp_f32 v76, v76
    v_exp_f32 v77, v77
    v_exp_f32 v78, v78
    s_waitcnt vmcnt(8)
    v_exp_f32 v79, v79
    v_cvt_pk_bf16_f32 v80, v64, v65
    v_cvt_pk_bf16_f32 v81, v66, v67
    v_cvt_pk_bf16_f32 v82, v68, v69
    v_cvt_pk_bf16_f32 v83, v70, v71
    v_cvt_pk_bf16_f32 v84, v72, v73
    v_cvt_pk_bf16_f32 v85, v74, v75
    v_cvt_pk_bf16_f32 v86, v76, v77
    v_cvt_pk_bf16_f32 v87, v78, v79
    v_mfma_f32_32x32x16_bf16 v[64:79], v[200:203], v[96:99], 0
    v_exp_f32 v48, v48
    v_exp_f32 v49, v49
    v_exp_f32 v50, v50
    v_mfma_f32_32x32x16_bf16 v[64:79], v[204:207], v[100:103], v[64:79]
    v_exp_f32 v51, v51
    v_exp_f32 v52, v52
    v_exp_f32 v53, v53
    v_mfma_f32_32x32x16_bf16 v[144:159], v[224:227], v[80:83], v[144:159]
    v_exp_f32 v54, v54
    v_exp_f32 v55, v55
    v_exp_f32 v56, v56
    v_mfma_f32_32x32x16_bf16 v[144:159], v[228:231], v[84:87], v[144:159]
    v_exp_f32 v57, v57
    v_exp_f32 v58, v58
    v_exp_f32 v59, v59
    v_exp_f32 v60, v60
    v_exp_f32 v61, v61
    v_exp_f32 v62, v62
    v_exp_f32 v63, v63
    v_cvt_pk_bf16_f32 v80, v48, v49
    v_cvt_pk_bf16_f32 v81, v50, v51
    v_cvt_pk_bf16_f32 v82, v52, v53
    v_cvt_pk_bf16_f32 v83, v54, v55
    v_cvt_pk_bf16_f32 v84, v56, v57
    v_cvt_pk_bf16_f32 v85, v58, v59
    v_cvt_pk_bf16_f32 v86, v60, v61
    v_cvt_pk_bf16_f32 v87, v62, v63
    v_mfma_f32_32x32x16_bf16 v[48:63], v[200:203], v[104:107], 0
    v_exp_f32 v64, v64
    v_exp_f32 v65, v65
    v_exp_f32 v66, v66
    v_mfma_f32_32x32x16_bf16 v[48:63], v[204:207], v[108:111], v[48:63]
    v_exp_f32 v67, v67
    v_exp_f32 v68, v68
    v_exp_f32 v69, v69
    v_mfma_f32_32x32x16_bf16 v[160:175], v[224:227], v[80:83], v[160:175]
    v_exp_f32 v70, v70
    v_exp_f32 v71, v71
    v_exp_f32 v72, v72
    v_mfma_f32_32x32x16_bf16 v[160:175], v[228:231], v[84:87], v[160:175]
    v_exp_f32 v73, v73
    v_exp_f32 v74, v74
    v_exp_f32 v75, v75
    v_exp_f32 v76, v76
    v_exp_f32 v77, v77
    v_exp_f32 v78, v78
    s_waitcnt vmcnt(4)
    v_exp_f32 v79, v79
    v_cvt_pk_bf16_f32 v80, v64, v65
    v_cvt_pk_bf16_f32 v81, v66, v67
    v_cvt_pk_bf16_f32 v82, v68, v69
    v_cvt_pk_bf16_f32 v83, v70, v71
    v_cvt_pk_bf16_f32 v84, v72, v73
    v_cvt_pk_bf16_f32 v85, v74, v75
    v_cvt_pk_bf16_f32 v86, v76, v77
    v_cvt_pk_bf16_f32 v87, v78, v79
    v_mfma_f32_32x32x16_bf16 v[64:79], v[208:211], v[96:99], 0
    v_exp_f32 v48, v48
    v_exp_f32 v49, v49
    v_exp_f32 v50, v50
    v_mfma_f32_32x32x16_bf16 v[64:79], v[212:215], v[100:103], v[64:79]
    v_exp_f32 v51, v51
    v_exp_f32 v52, v52
    v_exp_f32 v53, v53
    v_mfma_f32_32x32x16_bf16 v[128:143], v[232:235], v[80:83], v[128:143]
    v_exp_f32 v54, v54
    v_exp_f32 v55, v55
    v_exp_f32 v56, v56
    v_mfma_f32_32x32x16_bf16 v[128:143], v[236:239], v[84:87], v[128:143]
    v_exp_f32 v57, v57
    v_exp_f32 v58, v58
    v_exp_f32 v59, v59
    v_exp_f32 v60, v60
    v_exp_f32 v61, v61
    v_exp_f32 v62, v62
    v_exp_f32 v63, v63
    v_cvt_pk_bf16_f32 v80, v48, v49
    v_cvt_pk_bf16_f32 v81, v50, v51
    v_cvt_pk_bf16_f32 v82, v52, v53
    v_cvt_pk_bf16_f32 v83, v54, v55
    v_cvt_pk_bf16_f32 v84, v56, v57
    v_cvt_pk_bf16_f32 v85, v58, v59
    v_cvt_pk_bf16_f32 v86, v60, v61
    v_cvt_pk_bf16_f32 v87, v62, v63
    v_mfma_f32_32x32x16_bf16 v[48:63], v[208:211], v[104:107], 0
    v_exp_f32 v64, v64
    v_exp_f32 v65, v65
    v_exp_f32 v66, v66
    v_mfma_f32_32x32x16_bf16 v[48:63], v[212:215], v[108:111], v[48:63]
    v_exp_f32 v67, v67
    v_exp_f32 v68, v68
    v_exp_f32 v69, v69
    v_mfma_f32_32x32x16_bf16 v[144:159], v[232:235], v[80:83], v[144:159]
    v_exp_f32 v70, v70
    v_exp_f32 v71, v71
    v_exp_f32 v72, v72
    v_mfma_f32_32x32x16_bf16 v[144:159], v[236:239], v[84:87], v[144:159]
    v_exp_f32 v73, v73
    v_exp_f32 v74, v74
    v_exp_f32 v75, v75
    v_exp_f32 v76, v76
    v_exp_f32 v77, v77
    v_exp_f32 v78, v78
    s_waitcnt vmcnt(0)
    v_exp_f32 v79, v79
    v_cvt_pk_bf16_f32 v80, v64, v65
    v_cvt_pk_bf16_f32 v81, v66, v67
    v_cvt_pk_bf16_f32 v82, v68, v69
    v_cvt_pk_bf16_f32 v83, v70, v71
    v_cvt_pk_bf16_f32 v84, v72, v73
    v_cvt_pk_bf16_f32 v85, v74, v75
    v_cvt_pk_bf16_f32 v86, v76, v77
    v_cvt_pk_bf16_f32 v87, v78, v79
    v_mfma_f32_32x32x16_bf16 v[64:79], v[216:219], v[96:99], 0
    v_exp_f32 v48, v48
    v_exp_f32 v49, v49
    v_exp_f32 v50, v50
    v_mfma_f32_32x32x16_bf16 v[64:79], v[220:223], v[100:103], v[64:79]
    v_exp_f32 v51, v51
    v_exp_f32 v52, v52
    v_exp_f32 v53, v53
    v_mfma_f32_32x32x16_bf16 v[128:143], v[240:243], v[80:83], v[128:143]
    v_exp_f32 v54, v54
    v_exp_f32 v55, v55
    v_exp_f32 v56, v56
    v_mfma_f32_32x32x16_bf16 v[128:143], v[244:247], v[84:87], v[128:143]
    v_exp_f32 v57, v57
    v_exp_f32 v58, v58
    v_exp_f32 v59, v59
    v_exp_f32 v60, v60
    v_exp_f32 v61, v61
    v_exp_f32 v62, v62
    v_exp_f32 v63, v63
    v_cvt_pk_bf16_f32 v80, v48, v49
    v_cvt_pk_bf16_f32 v81, v50, v51
    v_cvt_pk_bf16_f32 v82, v52, v53
    v_cvt_pk_bf16_f32 v83, v54, v55
    v_cvt_pk_bf16_f32 v84, v56, v57
    v_cvt_pk_bf16_f32 v85, v58, v59
    v_cvt_pk_bf16_f32 v86, v60, v61
    v_cvt_pk_bf16_f32 v87, v62, v63
    v_mfma_f32_32x32x16_bf16 v[48:63], v[216:219], v[104:107], 0
    v_exp_f32 v64, v64
    v_exp_f32 v65, v65
    v_exp_f32 v66, v66
    v_mfma_f32_32x32x16_bf16 v[48:63], v[220:223], v[108:111], v[48:63]
    v_exp_f32 v67, v67
    v_exp_f32 v68, v68
    v_exp_f32 v69, v69
    v_mfma_f32_32x32x16_bf16 v[144:159], v[240:243], v[80:83], v[144:159]
    v_exp_f32 v70, v70
    v_exp_f32 v71, v71
    v_exp_f32 v72, v72
    v_mfma_f32_32x32x16_bf16 v[144:159], v[244:247], v[84:87], v[144:159]
    v_exp_f32 v73, v73
    v_exp_f32 v74, v74
    v_exp_f32 v75, v75
    v_exp_f32 v76, v76
    v_exp_f32 v77, v77
    v_exp_f32 v78, v78
    v_exp_f32 v79, v79
    v_cvt_pk_bf16_f32 v80, v64, v65
    v_cvt_pk_bf16_f32 v81, v66, v67
    v_cvt_pk_bf16_f32 v82, v68, v69
    v_cvt_pk_bf16_f32 v83, v70, v71
    v_cvt_pk_bf16_f32 v84, v72, v73
    v_cvt_pk_bf16_f32 v85, v74, v75
    v_cvt_pk_bf16_f32 v86, v76, v77
    v_cvt_pk_bf16_f32 v87, v78, v79
    v_mfma_f32_32x32x16_bf16 v[64:79], v[200:203], v[112:115], 0
    v_exp_f32 v48, v48
    v_exp_f32 v49, v49
    v_exp_f32 v50, v50
    v_mfma_f32_32x32x16_bf16 v[64:79], v[204:207], v[116:119], v[64:79]
    v_exp_f32 v51, v51
    v_exp_f32 v52, v52
    v_exp_f32 v53, v53
    v_mfma_f32_32x32x16_bf16 v[128:143], v[248:251], v[80:83], v[128:143]
    v_exp_f32 v54, v54
    v_exp_f32 v55, v55
    v_exp_f32 v56, v56
    v_mfma_f32_32x32x16_bf16 v[128:143], v[252:255], v[84:87], v[128:143]
    v_exp_f32 v57, v57
    v_exp_f32 v58, v58
    v_exp_f32 v59, v59
    v_exp_f32 v60, v60
    v_exp_f32 v61, v61
    v_exp_f32 v62, v62
    v_exp_f32 v63, v63
    v_cvt_pk_bf16_f32 v80, v48, v49
    v_cvt_pk_bf16_f32 v81, v50, v51
    v_cvt_pk_bf16_f32 v82, v52, v53
    v_cvt_pk_bf16_f32 v83, v54, v55
    v_cvt_pk_bf16_f32 v84, v56, v57
    v_cvt_pk_bf16_f32 v85, v58, v59
    v_cvt_pk_bf16_f32 v86, v60, v61
    v_cvt_pk_bf16_f32 v87, v62, v63
    v_mfma_f32_32x32x16_bf16 v[48:63], v[208:211], v[112:115], 0
    v_exp_f32 v64, v64
    v_exp_f32 v65, v65
    v_exp_f32 v66, v66
    v_mfma_f32_32x32x16_bf16 v[48:63], v[212:215], v[116:119], v[48:63]
    v_exp_f32 v67, v67
    v_exp_f32 v68, v68
    v_exp_f32 v69, v69
    v_mfma_f32_32x32x16_bf16 v[144:159], v[248:251], v[80:83], v[144:159]
    v_exp_f32 v70, v70
    v_exp_f32 v71, v71
    v_exp_f32 v72, v72
    v_mfma_f32_32x32x16_bf16 v[144:159], v[252:255], v[84:87], v[144:159]
    v_exp_f32 v73, v73
    v_exp_f32 v74, v74
    v_exp_f32 v75, v75
    ds_write_b128 v1, v[128:131] offset:0
    ds_write_b128 v1, v[132:135] offset:1024
    ds_write_b128 v1, v[136:139] offset:2048
    ds_write_b128 v1, v[140:143] offset:3072
    v_exp_f32 v76, v76
    v_exp_f32 v77, v77
    v_exp_f32 v78, v78
    v_exp_f32 v79, v79
    v_cvt_pk_bf16_f32 v80, v64, v65
    v_cvt_pk_bf16_f32 v81, v66, v67
    v_cvt_pk_bf16_f32 v82, v68, v69
    v_cvt_pk_bf16_f32 v83, v70, v71
    v_cvt_pk_bf16_f32 v84, v72, v73
    v_cvt_pk_bf16_f32 v85, v74, v75
    v_cvt_pk_bf16_f32 v86, v76, v77
    v_cvt_pk_bf16_f32 v87, v78, v79
    v_mfma_f32_32x32x16_bf16 v[64:79], v[216:219], v[112:115], 0
    v_exp_f32 v48, v48
    v_exp_f32 v49, v49
    v_exp_f32 v50, v50
    v_mfma_f32_32x32x16_bf16 v[64:79], v[220:223], v[116:119], v[64:79]
    v_exp_f32 v51, v51
    v_exp_f32 v52, v52
    v_exp_f32 v53, v53
    v_mfma_f32_32x32x16_bf16 v[160:175], v[232:235], v[80:83], v[160:175]
    v_exp_f32 v54, v54
    v_exp_f32 v55, v55
    v_exp_f32 v56, v56
    v_mfma_f32_32x32x16_bf16 v[160:175], v[236:239], v[84:87], v[160:175]
    v_exp_f32 v57, v57
    v_exp_f32 v58, v58
    v_exp_f32 v59, v59
    ds_write_b128 v2, v[144:147] offset:0
    ds_write_b128 v2, v[148:151] offset:1024
    ds_write_b128 v2, v[152:155] offset:2048
    ds_write_b128 v2, v[156:159] offset:3072
    s_mov_b64 exec, 1
    ds_add_u32 v25, v26 offset:20
    s_mov_b64 exec, -1
    v_exp_f32 v60, v60
    v_exp_f32 v61, v61
    v_exp_f32 v62, v62
    v_exp_f32 v63, v63
    v_cvt_pk_bf16_f32 v80, v48, v49
    v_cvt_pk_bf16_f32 v81, v50, v51
    v_cvt_pk_bf16_f32 v82, v52, v53
    v_cvt_pk_bf16_f32 v83, v54, v55
    v_cvt_pk_bf16_f32 v84, v56, v57
    v_cvt_pk_bf16_f32 v85, v58, v59
    v_cvt_pk_bf16_f32 v86, v60, v61
    v_cvt_pk_bf16_f32 v87, v62, v63
    v_mfma_f32_32x32x16_bf16 v[48:63], v[192:195], v[120:123], 0
    v_exp_f32 v64, v64
    v_exp_f32 v65, v65
    v_exp_f32 v66, v66
    v_mfma_f32_32x32x16_bf16 v[48:63], v[196:199], v[124:127], v[48:63]
    v_exp_f32 v67, v67
    v_exp_f32 v68, v68
    v_exp_f32 v69, v69
    v_mfma_f32_32x32x16_bf16 v[160:175], v[240:243], v[80:83], v[160:175]
    v_exp_f32 v70, v70
    v_exp_f32 v71, v71
    v_exp_f32 v72, v72
    v_mfma_f32_32x32x16_bf16 v[160:175], v[244:247], v[84:87], v[160:175]
    v_exp_f32 v73, v73
    v_exp_f32 v74, v74
    v_exp_f32 v75, v75
    v_exp_f32 v76, v76
    v_exp_f32 v77, v77
    v_exp_f32 v78, v78
    v_exp_f32 v79, v79
    v_cvt_pk_bf16_f32 v80, v64, v65
    v_cvt_pk_bf16_f32 v81, v66, v67
    v_cvt_pk_bf16_f32 v82, v68, v69
    v_cvt_pk_bf16_f32 v83, v70, v71
    v_cvt_pk_bf16_f32 v84, v72, v73
    v_cvt_pk_bf16_f32 v85, v74, v75
    v_cvt_pk_bf16_f32 v86, v76, v77
    v_cvt_pk_bf16_f32 v87, v78, v79
    ds_read_b32 v5, v25 offset:20
    v_mfma_f32_32x32x16_bf16 v[64:79], v[200:203], v[120:123], 0
    v_exp_f32 v48, v48
    v_exp_f32 v49, v49
    v_exp_f32 v50, v50
    v_mfma_f32_32x32x16_bf16 v[64:79], v[204:207], v[124:127], v[64:79]
    v_exp_f32 v51, v51
    v_exp_f32 v52, v52
    v_exp_f32 v53, v53
    v_mfma_f32_32x32x16_bf16 v[160:175], v[248:251], v[80:83], v[160:175]
    v_exp_f32 v54, v54
    v_exp_f32 v55, v55
    v_exp_f32 v56, v56
    v_mfma_f32_32x32x16_bf16 v[160:175], v[252:255], v[84:87], v[160:175]
    v_exp_f32 v57, v57
    v_exp_f32 v58, v58
    v_exp_f32 v59, v59
    s_waitcnt lgkmcnt(0)
    v_readfirstlane_b32 s63, v5
    s_mov_b32 s62, 1048576
    s_bitcmp1_b32 s63, 2
    s_cbranch_scc1 L_rca_x
L_rca:
    ds_read_b32 v5, v25 offset:20
    s_waitcnt lgkmcnt(0)
    v_readfirstlane_b32 s63, v5
    s_sub_u32 s62, s62, 1
    s_cmp_eq_u32 s62, 0
    s_cbranch_scc1 L_rca_x
    s_bitcmp0_b32 s63, 2
    s_cbranch_scc1 L_rca
L_rca_x:
    ds_read_b128 v[128:131], v4 offset:0
    ds_read_b128 v[132:135], v4 offset:1024
    ds_read_b128 v[136:139], v4 offset:2048
    ds_read_b128 v[140:143], v4 offset:3072
    ds_read_b128 v[144:147], v4 offset:4096
    ds_read_b128 v[148:151], v4 offset:5120
    ds_read_b128 v[152:155], v4 offset:6144
    ds_read_b128 v[156:159], v4 offset:7168
    v_exp_f32 v60, v60
    v_exp_f32 v61, v61
    v_exp_f32 v62, v62
    v_exp_f32 v63, v63
    v_cvt_pk_bf16_f32 v80, v48, v49
    v_cvt_pk_bf16_f32 v81, v50, v51
    v_cvt_pk_bf16_f32 v82, v52, v53
    v_cvt_pk_bf16_f32 v83, v54, v55
    v_cvt_pk_bf16_f32 v84, v56, v57
    v_cvt_pk_bf16_f32 v85, v58, v59
    v_cvt_pk_bf16_f32 v86, v60, v61
    v_cvt_pk_bf16_f32 v87, v62, v63
    s_waitcnt lgkmcnt(0)
    v_add_f32 v176, v176, v128
    v_add_f32 v177, v177, v129
    v_add_f32 v178, v178, v130
    v_add_f32 v179, v179, v131
    v_add_f32 v180, v180, v132
    v_add_f32 v181, v181, v133
    v_add_f32 v182, v182, v134
    v_add_f32 v183, v183, v135
    v_add_f32 v184, v184, v136
    v_add_f32 v185, v185, v137
    v_add_f32 v186, v186, v138
    v_add_f32 v187, v187, v139
    v_add_f32 v188, v188, v140
    v_add_f32 v189, v189, v141
    v_add_f32 v190, v190, v142
    v_add_f32 v191, v191, v143
    v_add_f32 v176, v176, v144
    v_add_f32 v177, v177, v145
    v_add_f32 v178, v178, v146
    v_add_f32 v179, v179, v147
    v_add_f32 v180, v180, v148
    v_add_f32 v181, v181, v149
    v_add_f32 v182, v182, v150
    v_add_f32 v183, v183, v151
    v_add_f32 v184, v184, v152
    v_add_f32 v185, v185, v153
    v_add_f32 v186, v186, v154
    v_add_f32 v187, v187, v155
    v_add_f32 v188, v188, v156
    v_add_f32 v189, v189, v157
    v_add_f32 v190, v190, v158
    v_add_f32 v191, v191, v159
    v_mfma_f32_32x32x16_bf16 v[48:63], v[208:211], v[120:123], 0
    v_exp_f32 v64, v64
    v_exp_f32 v65, v65
    v_exp_f32 v66, v66
    v_mfma_f32_32x32x16_bf16 v[48:63], v[212:215], v[124:127], v[48:63]
    v_exp_f32 v67, v67
    v_exp_f32 v68, v68
    v_exp_f32 v69, v69
    v_mfma_f32_32x32x16_bf16 v[176:191], v[224:227], v[80:83], v[176:191]
    v_exp_f32 v70, v70
    v_exp_f32 v71, v71
    v_exp_f32 v72, v72
    v_mfma_f32_32x32x16_bf16 v[176:191], v[228:231], v[84:87], v[176:191]
    v_exp_f32 v73, v73
    v_exp_f32 v74, v74
    v_exp_f32 v75, v75
    ds_write_b128 v3, v[160:163] offset:0
    ds_write_b128 v3, v[164:167] offset:1024
    ds_write_b128 v3, v[168:171] offset:2048
    ds_write_b32 v3, v172 offset:3072
    s_mov_b32 exec_hi, 0
    ds_write_b128 v3, v[172:175] offset:3072
    s_mov_b32 exec_lo, 1
    ds_add_u32 v25, v6 offset:20
    s_mov_b64 exec, -1
    v_exp_f32 v76, v76
    v_exp_f32 v77, v77
    v_exp_f32 v78, v78
    v_exp_f32 v79, v79
    v_cvt_pk_bf16_f32 v80, v64, v65
    v_cvt_pk_bf16_f32 v81, v66, v67
    v_cvt_pk_bf16_f32 v82, v68, v69
    v_cvt_pk_bf16_f32 v83, v70, v71
    v_cvt_pk_bf16_f32 v84, v72, v73
    v_cvt_pk_bf16_f32 v85, v74, v75
    v_cvt_pk_bf16_f32 v86, v76, v77
    v_cvt_pk_bf16_f32 v87, v78, v79
    v_mfma_f32_32x32x16_bf16 v[64:79], v[216:219], v[120:123], 0
    v_exp_f32 v48, v48
    v_exp_f32 v49, v49
    v_exp_f32 v50, v50
    v_mfma_f32_32x32x16_bf16 v[64:79], v[220:223], v[124:127], v[64:79]
    v_exp_f32 v51, v51
    v_exp_f32 v52, v52
    v_exp_f32 v53, v53
    v_mfma_f32_32x32x16_bf16 v[176:191], v[232:235], v[80:83], v[176:191]
    v_exp_f32 v54, v54
    v_exp_f32 v55, v55
    v_exp_f32 v56, v56
    v_mfma_f32_32x32x16_bf16 v[176:191], v[236:239], v[84:87], v[176:191]
    v_exp_f32 v57, v57
    v_exp_f32 v58, v58
    v_exp_f32 v59, v59
    v_exp_f32 v60, v60
    v_exp_f32 v61, v61
    v_exp_f32 v62, v62
    v_exp_f32 v63, v63
    v_cvt_pk_bf16_f32 v80, v48, v49
    v_cvt_pk_bf16_f32 v81, v50, v51
    v_cvt_pk_bf16_f32 v82, v52, v53
    v_cvt_pk_bf16_f32 v83, v54, v55
    v_cvt_pk_bf16_f32 v84, v56, v57
    v_cvt_pk_bf16_f32 v85, v58, v59
    v_cvt_pk_bf16_f32 v86, v60, v61
    v_cvt_pk_bf16_f32 v87, v62, v63
    v_exp_f32 v64, v64
    v_exp_f32 v65, v65
    v_exp_f32 v66, v66
    v_exp_f32 v67, v67
    v_exp_f32 v68, v68
    v_exp_f32 v69, v69
    v_mfma_f32_32x32x16_bf16 v[176:191], v[240:243], v[80:83], v[176:191]
    v_exp_f32 v70, v70
    v_exp_f32 v71, v71
    v_exp_f32 v72, v72
    v_mfma_f32_32x32x16_bf16 v[176:191], v[244:247], v[84:87], v[176:191]
    v_exp_f32 v73, v73
    v_exp_f32 v74, v74
    v_exp_f32 v75, v75
    ds_read_b32 v5, v25 offset:20
    v_exp_f32 v76, v76
    v_exp_f32 v77, v77
    v_exp_f32 v78, v78
    v_exp_f32 v79, v79
    v_cvt_pk_bf16_f32 v80, v64, v65
    v_cvt_pk_bf16_f32 v81, v66, v67
    v_cvt_pk_bf16_f32 v82, v68, v69
    v_cvt_pk_bf16_f32 v83, v70, v71
    v_cvt_pk_bf16_f32 v84, v72, v73
    v_cvt_pk_bf16_f32 v85, v74, v75
    v_cvt_pk_bf16_f32 v86, v76, v77
    v_cvt_pk_bf16_f32 v87, v78, v79
    s_waitcnt lgkmcnt(0)
    v_readfirstlane_b32 s63, v5
    s_mov_b32 s62, 1048576
    s_bitcmp1_b32 s63, 10
    s_cbranch_scc1 L_rcb_x
L_rcb:
    ds_read_b32 v5, v25 offset:20
    s_waitcnt lgkmcnt(0)
    v_readfirstlane_b32 s63, v5
    s_sub_u32 s62, s62, 1
    s_cmp_eq_u32 s62, 0
    s_cbranch_scc1 L_rcb_x
    s_bitcmp0_b32 s63, 10
    s_cbranch_scc1 L_rcb
L_rcb_x:
    ds_read_b128 v[128:131], v4 offset:8192
    ds_read_b128 v[132:135], v4 offset:9216
    ds_read_b128 v[136:139], v4 offset:10240
    ds_read_b128 v[140:143], v4 offset:11264
    s_setprio 3
    v_mfma_f32_32x32x16_bf16 v[176:191], v[248:251], v[80:83], v[176:191]
    v_mfma_f32_32x32x16_bf16 v[176:191], v[252:255], v[84:87], v[176:191]
    v_cmp_eq_u32 vcc, 0, v31
    s_waitcnt lgkmcnt(0)
    s_nop 9
    v_add_f32 v176, v176, v128
    v_add_f32 v177, v177, v129
    v_add_f32 v178, v178, v130
    v_add_f32 v179, v179, v131
    v_add_f32 v180, v180, v132
    v_add_f32 v181, v181, v133
    v_add_f32 v182, v182, v134
    v_add_f32 v183, v183, v135
    v_add_f32 v184, v184, v136
    v_add_f32 v185, v185, v137
    v_add_f32 v186, v186, v138
    v_add_f32 v187, v187, v139
    v_add_f32 v188, v188, v140
    v_add_f32 v189, v189, v141
    v_add_f32 v190, v190, v142
    v_add_f32 v191, v191, v143
    v_mov_b32 v4, v188
    v_mov_b32 v5, v188
    v_cndmask_b32 v189, 0, v189, vcc
    v_cndmask_b32 v190, 0, v190, vcc
    v_cndmask_b32 v191, 0, v191, vcc
    v_permlane32_swap_b32 v4, v5
    v_add_f32 v10, v176, v177
    v_add_f32 v11, v178, v179
    v_rcp_f32 v4, v5
    v_add_f32 v10, v10, v180
    v_add_f32 v11, v11, v181
    v_add_f32 v10, v10, v182
    v_add_f32 v11, v11, v183
    v_add_f32 v10, v10, v184
    v_add_f32 v11, v11, v185
    v_add_f32 v10, v10, v186
    v_add_f32 v11, v11, v187
    v_add_f32 v10, v10, v188
    v_add_f32 v11, v11, v189
    v_add_f32 v10, v10, v190
    v_add_f32 v11, v11, v191
    v_cmp_ge_f32 s[66:67], v7, v5
    v_cmp_le_f32 s[68:69], v8, v5
    v_add_f32 v6, v10, v11
    v_cmp_gt_f32 s[70:71], v9, |v6|
    v_mul_f32 v4, v93, v4
    s_and_b64 s[66:67], s[66:67], s[68:69]
    s_and_b64 s[66:67], s[66:67], s[70:71]
    s_cmp_eq_u64 s[66:67], -1
    s_cbranch_scc0 L_fb
L_norm:
    v_mul_f32 v176, v4, v176
    v_mul_f32 v177, v4, v177
    v_mul_f32 v178, v4, v178
    v_mul_f32 v179, v4, v179
    v_mul_f32 v180, v4, v180
    v_mul_f32 v181, v4, v181
    v_mul_f32 v182, v4, v182
    v_mul_f32 v183, v4, v183
    v_cvt_pk_bf16_f32 v80, v176, v177
    v_cvt_pk_bf16_f32 v81, v178, v179
    v_cvt_pk_bf16_f32 v82, v180, v181
    v_cvt_pk_bf16_f32 v83, v182, v183
    v_min_u32 v80, -2, v80
    v_min_u32 v81, -2, v81
    v_min_u32 v82, -2, v82
    v_min_u32 v83, -2, v83
    buffer_store_dwordx4 v[80:83], v29, s[28:31], s65 offen sc1
    v_mul_f32 v184, v4, v184
    v_mul_f32 v185, v4, v185
    v_mul_f32 v186, v4, v186
    v_mul_f32 v187, v4, v187
    v_mul_f32 v188, v4, v188
    v_mul_f32 v189, v4, v189
    v_mul_f32 v190, v4, v190
    v_mul_f32 v191, v4, v191
    v_cvt_pk_bf16_f32 v84, v184, v185
    v_cvt_pk_bf16_f32 v85, v186, v187
    v_cvt_pk_bf16_f32 v86, v188, v189
    v_cvt_pk_bf16_f32 v87, v190, v191
    v_cndmask_b32 v86, 0, v86, vcc
    v_cndmask_b32 v87, 0, v87, vcc
    v_min_u32 v84, -2, v84
    v_min_u32 v85, -2, v85
    v_min_u32 v86, -2, v86
    v_min_u32 v87, -2, v87
    buffer_store_dwordx4 v[84:87], v29, s[28:31], s65 offen offset:1024 sc1
    s_mov_b64 exec, 1
    ds_add_u32 v25, v26 offset:36
    s_mov_b64 exec, -1
    s_endpgm
L_fb:
    v_cmp_eq_u32 vcc, 0, v31
    v_mov_b32 v4, 0xff800000
    s_mov_b32 s60, 0
    v_cndmask_b32 v126, 0, v126, vcc
L_fb1:
    buffer_load_dwordx4 v[192:195], v29, s[28:31], s60 offen sc1
    buffer_load_dwordx4 v[196:199], v29, s[28:31], s60 offen offset:1024 sc1
    s_waitcnt vmcnt(0)
    v_mfma_f32_32x32x16_bf16 v[48:63], v[192:195], v[120:123], 0
    v_mfma_f32_32x32x16_bf16 v[48:63], v[196:199], v[124:127], v[48:63]
    s_nop 11
    v_max3_f32 v4, v4, v48, v49
    v_max3_f32 v4, v4, v50, v51
    v_max3_f32 v4, v4, v52, v53
    v_max3_f32 v4, v4, v54, v55
    v_max3_f32 v4, v4, v56, v57
    v_max3_f32 v4, v4, v58, v59
    v_max3_f32 v4, v4, v60, v61
    v_max3_f32 v4, v4, v62, v63
    s_add_u32 s60, s60, 4096
    s_cmp_lt_u32 s60, 0x40000
    s_cbranch_scc1 L_fb1
    v_mov_b32 v5, v4
    s_nop 1
    v_permlane32_swap_b32 v4, v5
    s_nop 0
    v_max_f32 v4, v4, v5
    v_mov_b32 v176, 0
    v_mov_b32 v177, 0
    v_mov_b32 v178, 0
    v_mov_b32 v179, 0
    v_mov_b32 v180, 0
    v_mov_b32 v181, 0
    v_mov_b32 v182, 0
    v_mov_b32 v183, 0
    v_mov_b32 v184, 0
    v_mov_b32 v185, 0
    v_mov_b32 v186, 0
    v_mov_b32 v187, 0
    v_mov_b32 v188, 0
    v_mov_b32 v189, 0
    v_mov_b32 v190, 0
    v_mov_b32 v191, 0
    s_mov_b32 s60, 0
L_fb2:
    buffer_load_dwordx4 v[192:195], v29, s[28:31], s60 offen sc1
    buffer_load_dwordx4 v[196:199], v29, s[28:31], s60 offen offset:1024 sc1
    buffer_load_dwordx4 v[224:227], v29, s[28:31], s60 offen offset:2048 sc1
    buffer_load_dwordx4 v[228:231], v29, s[28:31], s60 offen offset:3072 sc1
    s_waitcnt vmcnt(0)
    v_mfma_f32_32x32x16_bf16 v[48:63], v[192:195], v[120:123], 0
    v_mfma_f32_32x32x16_bf16 v[48:63], v[196:199], v[124:127], v[48:63]
    s_nop 11
    v_sub_f32 v48, v48, v4
    v_sub_f32 v49, v49, v4
    v_sub_f32 v50, v50, v4
    v_sub_f32 v51, v51, v4
    v_sub_f32 v52, v52, v4
    v_sub_f32 v53, v53, v4
    v_sub_f32 v54, v54, v4
    v_sub_f32 v55, v55, v4
    v_sub_f32 v56, v56, v4
    v_sub_f32 v57, v57, v4
    v_sub_f32 v58, v58, v4
    v_sub_f32 v59, v59, v4
    v_sub_f32 v60, v60, v4
    v_sub_f32 v61, v61, v4
    v_sub_f32 v62, v62, v4
    v_sub_f32 v63, v63, v4
    v_exp_f32 v48, v48
    v_exp_f32 v49, v49
    v_exp_f32 v50, v50
    v_exp_f32 v51, v51
    v_exp_f32 v52, v52
    v_exp_f32 v53, v53
    v_exp_f32 v54, v54
    v_exp_f32 v55, v55
    v_exp_f32 v56, v56
    v_exp_f32 v57, v57
    v_exp_f32 v58, v58
    v_exp_f32 v59, v59
    v_exp_f32 v60, v60
    v_exp_f32 v61, v61
    v_exp_f32 v62, v62
    v_exp_f32 v63, v63
    s_nop 0
    v_cvt_pk_bf16_f32 v80, v48, v49
    v_cvt_pk_bf16_f32 v81, v50, v51
    v_cvt_pk_bf16_f32 v82, v52, v53
    v_cvt_pk_bf16_f32 v83, v54, v55
    v_cvt_pk_bf16_f32 v84, v56, v57
    v_cvt_pk_bf16_f32 v85, v58, v59
    v_cvt_pk_bf16_f32 v86, v60, v61
    v_cvt_pk_bf16_f32 v87, v62, v63
    s_nop 1
    v_mfma_f32_32x32x16_bf16 v[176:191], v[224:227], v[80:83], v[176:191]
    v_mfma_f32_32x32x16_bf16 v[176:191], v[228:231], v[84:87], v[176:191]
    s_add_u32 s60, s60, 4096
    s_cmp_lt_u32 s60, 0x40000
    s_cbranch_scc1 L_fb2
    s_nop 11
    v_mov_b32 v4, v188
    v_mov_b32 v5, v188
    s_nop 1
    v_permlane32_swap_b32 v4, v5
    s_nop 0
    v_rcp_f32 v4, v5
    s_nop 0
    v_mul_f32 v4, v93, v4
    s_branch L_norm
L_g:
    s_load_dwordx2 s[20:21], s[0:1], 64
    s_load_dwordx2 s[24:25], s[0:1], 32
    s_load_dwordx2 s[32:33], s[0:1], 80
    s_mov_b32 s22, 1605632
    s_mov_b32 s23, 0x20000
    s_mov_b32 s26, 401408
    s_mov_b32 s27, 0x20000
    s_mov_b32 s34, 1835008
    s_mov_b32 s35, 0x20000
    s_lshl_b32 s48, s68, 2
    s_and_b32 s70, s69, 3
    s_add_u32 s48, s48, s70
    s_xor_b32 s49, s49, 7
    s_cmp_ge_u32 s47, 14
    s_cbranch_scc1 L_gk
L_gf:
    v_and_b32 v24, 31, v0
    v_bfe_u32 v25, v0, 1, 3
    v_xor_b32 v25, v25, v31
    v_lshlrev_b32 v25, 4, v25
    v_lshl_add_u32 v30, v24, 7, v25
    v_bfe_u32 v28, v0, 2, 2
    v_bfe_u32 v24, v0, 4, 1
    v_and_b32 v25, 3, v0
    v_lshlrev_b32 v25, 3, v25
    v_lshl_add_u32 v27, v24, 5, v25
    s_and_b32 s52, s45, 1
    s_lshr_b32 s53, s45, 1
    s_lshl_b32 s70, s52, 13
    v_add_u32 v1, s70, v30
    v_xor_b32 v2, 32, v1
    v_xor_b32 v3, 64, v1
    v_xor_b32 v4, 96, v1
    v_bfe_u32 v17, v0, 4, 1
    v_lshl_add_u32 v18, v17, 2, v28
    s_lshl_b32 s70, s53, 2
    v_xor_b32 v18, s70, v18
    v_lshlrev_b32 v18, 5, v18
    v_and_b32 v19, 3, v0
    v_lshl_add_u32 v18, v19, 3, v18
    v_lshl_add_u32 v19, v31, 3, v28
    v_lshl_add_u32 v18, v19, 8, v18
    v_lshl_add_u32 v18, v17, 14, v18
    v_add_u32 v5, 16384, v18
    v_xor_b32 v6, 32, v5
    v_xor_b32 v7, 64, v5
    v_xor_b32 v8, 96, v5
    v_add_u32 v9, 53248, v1
    v_add_u32 v112, 106496, v1
    v_add_u32 v10, 53248, v2
    v_add_u32 v113, 106496, v2
    v_add_u32 v11, 53248, v3
    v_add_u32 v114, 106496, v3
    v_add_u32 v12, 53248, v4
    v_add_u32 v115, 106496, v4
    v_add_u32 v13, 53248, v5
    v_add_u32 v116, 106496, v5
    v_add_u32 v14, 53248, v6
    v_add_u32 v117, 106496, v6
    v_add_u32 v15, 53248, v7
    v_add_u32 v118, 106496, v7
    v_add_u32 v16, 53248, v8
    v_add_u32 v119, 106496, v8
    s_add_u32 s13, s45, s49
    s_add_u32 s13, s13, s48
    s_and_b32 s13, s13, 3
    s_lshl_b32 s13, s13, 1
    s_lshr_b32 s14, s49, 2
    s_lshr_b32 s70, s48, 1
    s_xor_b32 s14, s14, s70
    s_and_b32 s14, s14, 1
    s_add_u32 s13, s13, s14
    s_xor_b32 s14, s13, 1
    s_and_b32 s70, s49, 1
    s_lshl_b32 s70, s70, 1
    s_xor_b32 s8, s45, s70
    s_and_b32 s9, s8, 1
    s_lshr_b32 s10, s8, 1
    s_lshl_b32 s12, s8, 11
    v_lshrrev_b32 v17, 3, v0
    v_mul_u32_u24 v17, 896, v17
    v_bfe_u32 v18, v0, 4, 1
    v_lshlrev_b32 v18, 2, v18
    v_and_b32 v19, 7, v0
    v_xor_b32 v18, v18, v19
    v_lshl_add_u32 v32, v18, 4, v17
    v_add_u32 v33, 6144, v32
    v_lshl_add_u32 v17, v31, 2, v28
    v_lshl_add_u32 v17, v17, 7, v27
    v_lshrrev_b32 v18, 1, v28
    v_xor_b32 v18, s10, v18
    v_lshl_add_u32 v17, v18, 6, v17
    v_add_u32 v34, s12, v17
    v_xor_b32 v35, 64, v34
    v_add_u32 v36, 0x10000, v34
    v_add_u32 v37, 0x10000, v35
    s_lshl_b32 s70, s10, 12
    v_add_u32 v38, s70, v17
    v_xor_b32 v39, 64, v38
    s_lshl_b32 s11, s48, 1
    s_add_u32 s11, s11, s9
    s_xor_b32 s70, s11, 1
    s_mul_i32 s71, s11, 114688
    s_add_u32 s71, s71, 3145728
    v_add_u32 v40, s71, v29
    s_mul_i32 s71, s70, 114688
    s_add_u32 s71, s71, 3145728
    v_add_u32 v41, s71, v29
    s_lshl_b32 s15, s49, 7
    s_mul_i32 s16, s13, 200704
    s_add_u32 s16, s16, s15
    s_mov_b32 s17, s12
    v_and_b32 v19, 31, v0
    v_lshlrev_b32 v42, 2, v19
    v_min_u32 v43, 15, v0
    v_lshlrev_b32 v43, 7, v43
    v_mul_u32_u24 v44, 3584, v0
    s_lshl_b32 s70, s11, 4
    s_lshl_b32 s71, s10, 3
    s_add_u32 s70, s70, s71
    s_lshl_b32 s70, s70, 11
    s_add_u32 s70, s70, 524288
    v_add_u32 v45, s70, v29
    v_add_u32 v46, 1024, v45
    v_add_u32 v47, s12, v29
    v_add_u32 v47, 0x10000, v47
    v_xor_b32 v48, 2048, v47
    v_xor_b32 v49, 4096, v47
    v_mul_u32_u24 v50, 896, v19
    v_lshl_add_u32 v50, v31, 4, v50
    v_mov_b32 v25, 163792
    v_mov_b32 v26, 1
    s_lshl_b32 s56, s46, 2
    s_lshl_b32 s70, s52, 1
    s_add_u32 s56, s56, s70
    s_mul_i32 s56, s56, 114688
    s_lshl_b32 s70, s47, 13
    s_add_u32 s56, s56, s70
    s_lshl_b32 s70, s53, 12
    s_add_u32 s56, s56, s70
    s_add_u32 s56, s56, 3145728
    s_add_u32 s57, s56, 114688
    s_waitcnt lgkmcnt(0)
    s_barrier
    s_lshl_b32 s65, s46, 2
    s_add_u32 s65, s65, s45
    s_lshl_b32 s65, s65, 4
    s_add_u32 s65, s65, s50
    s_lshl_b32 s65, s65, 11
    s_add_u32 s65, s65, 524288
    v_mov_b32 v56, -1
    v_mov_b32 v57, -1
    v_mov_b32 v58, -1
    v_mov_b32 v59, -1
    buffer_store_dwordx4 v[56:59], v29, s[28:31], s65 offen offset:0 sc1
    buffer_store_dwordx4 v[56:59], v29, s[28:31], s65 offen offset:1024 sc1
    s_barrier
    ds_read_b128 v[64:67], v112
    ds_read_b64_tr_b16 v[80:81], v116 offset:0
    ds_read_b64_tr_b16 v[82:83], v116 offset:1024
    ds_read_b128 v[68:71], v112 offset:4096
    ds_read_b64_tr_b16 v[84:85], v117 offset:0
    ds_read_b64_tr_b16 v[86:87], v117 offset:1024
    ds_read_b64_tr_b16 v[88:89], v118 offset:0
    ds_read_b64_tr_b16 v[90:91], v118 offset:1024
    ds_read_b64_tr_b16 v[92:93], v119 offset:0
    ds_read_b64_tr_b16 v[94:95], v119 offset:1024
    s_waitcnt lgkmcnt(0)
    v_mfma_f32_32x32x16_bf16 v[128:143], v[80:83], v[64:67], 0
    ds_read_b128 v[72:75], v113
    ds_read_b64_tr_b16 v[96:97], v116 offset:4096
    v_mfma_f32_32x32x16_bf16 v[192:207], v[80:83], v[68:71], 0
    ds_read_b64_tr_b16 v[98:99], v116 offset:5120
    ds_read_b128 v[76:79], v113 offset:4096
    v_mfma_f32_32x32x16_bf16 v[144:159], v[84:87], v[64:67], 0
    ds_read_b64_tr_b16 v[100:101], v117 offset:4096
    ds_read_b64_tr_b16 v[102:103], v117 offset:5120
    v_mfma_f32_32x32x16_bf16 v[208:223], v[84:87], v[68:71], 0
    ds_read_b64_tr_b16 v[104:105], v118 offset:4096
    ds_read_b64_tr_b16 v[106:107], v118 offset:5120
    v_mfma_f32_32x32x16_bf16 v[160:175], v[88:91], v[64:67], 0
    ds_read_b64_tr_b16 v[108:109], v119 offset:4096
    ds_read_b64_tr_b16 v[110:111], v119 offset:5120
    v_mfma_f32_32x32x16_bf16 v[224:239], v[88:91], v[68:71], 0
    v_mfma_f32_32x32x16_bf16 v[176:191], v[92:95], v[64:67], 0
    v_mfma_f32_32x32x16_bf16 v[240:255], v[92:95], v[68:71], 0
    s_waitcnt lgkmcnt(0)
    v_mfma_f32_32x32x16_bf16 v[128:143], v[96:99], v[72:75], v[128:143]
    s_barrier
    ds_read_b128 v[64:67], v114
    ds_read_b64_tr_b16 v[80:81], v116 offset:8192
    v_mfma_f32_32x32x16_bf16 v[192:207], v[96:99], v[76:79], v[192:207]
    ds_read_b64_tr_b16 v[82:83], v116 offset:9216
    ds_read_b128 v[68:71], v114 offset:4096
    v_mfma_f32_32x32x16_bf16 v[144:159], v[100:103], v[72:75], v[144:159]
    ds_read_b64_tr_b16 v[84:85], v117 offset:8192
    ds_read_b64_tr_b16 v[86:87], v117 offset:9216
    v_mfma_f32_32x32x16_bf16 v[208:223], v[100:103], v[76:79], v[208:223]
    ds_read_b64_tr_b16 v[88:89], v118 offset:8192
    ds_read_b64_tr_b16 v[90:91], v118 offset:9216
    v_mfma_f32_32x32x16_bf16 v[160:175], v[104:107], v[72:75], v[160:175]
    ds_read_b64_tr_b16 v[92:93], v119 offset:8192
    ds_read_b64_tr_b16 v[94:95], v119 offset:9216
    v_mfma_f32_32x32x16_bf16 v[224:239], v[104:107], v[76:79], v[224:239]
    v_mfma_f32_32x32x16_bf16 v[176:191], v[108:111], v[72:75], v[176:191]
    v_mfma_f32_32x32x16_bf16 v[240:255], v[108:111], v[76:79], v[240:255]
    s_waitcnt lgkmcnt(0)
    v_mfma_f32_32x32x16_bf16 v[128:143], v[80:83], v[64:67], v[128:143]
    ds_read_b128 v[72:75], v115
    ds_read_b64_tr_b16 v[96:97], v116 offset:12288
    v_mfma_f32_32x32x16_bf16 v[192:207], v[80:83], v[68:71], v[192:207]
    ds_read_b64_tr_b16 v[98:99], v116 offset:13312
    ds_read_b128 v[76:79], v115 offset:4096
    v_mfma_f32_32x32x16_bf16 v[144:159], v[84:87], v[64:67], v[144:159]
    ds_read_b64_tr_b16 v[100:101], v117 offset:12288
    ds_read_b64_tr_b16 v[102:103], v117 offset:13312
    v_mfma_f32_32x32x16_bf16 v[208:223], v[84:87], v[68:71], v[208:223]
    ds_read_b64_tr_b16 v[104:105], v118 offset:12288
    ds_read_b64_tr_b16 v[106:107], v118 offset:13312
    v_mfma_f32_32x32x16_bf16 v[160:175], v[88:91], v[64:67], v[160:175]
    ds_read_b64_tr_b16 v[108:109], v119 offset:12288
    ds_read_b64_tr_b16 v[110:111], v119 offset:13312
    v_mfma_f32_32x32x16_bf16 v[224:239], v[88:91], v[68:71], v[224:239]
    v_mfma_f32_32x32x16_bf16 v[176:191], v[92:95], v[64:67], v[176:191]
    v_mfma_f32_32x32x16_bf16 v[240:255], v[92:95], v[68:71], v[240:255]
    s_waitcnt lgkmcnt(0)
    v_mfma_f32_32x32x16_bf16 v[128:143], v[96:99], v[72:75], v[128:143]
    s_barrier
    ds_read_b128 v[64:67], v1
    ds_read_b64_tr_b16 v[80:81], v5 offset:0
    v_mfma_f32_32x32x16_bf16 v[192:207], v[96:99], v[76:79], v[192:207]
    ds_read_b64_tr_b16 v[82:83], v5 offset:1024
    ds_read_b128 v[68:71], v1 offset:4096
    v_mfma_f32_32x32x16_bf16 v[144:159], v[100:103], v[72:75], v[144:159]
    ds_read_b64_tr_b16 v[84:85], v6 offset:0
    ds_read_b64_tr_b16 v[86:87], v6 offset:1024
    v_mfma_f32_32x32x16_bf16 v[208:223], v[100:103], v[76:79], v[208:223]
    ds_read_b64_tr_b16 v[88:89], v7 offset:0
    ds_read_b64_tr_b16 v[90:91], v7 offset:1024
    v_mfma_f32_32x32x16_bf16 v[160:175], v[104:107], v[72:75], v[160:175]
    ds_read_b64_tr_b16 v[92:93], v8 offset:0
    ds_read_b64_tr_b16 v[94:95], v8 offset:1024
    v_mfma_f32_32x32x16_bf16 v[224:239], v[104:107], v[76:79], v[224:239]
    v_mfma_f32_32x32x16_bf16 v[176:191], v[108:111], v[72:75], v[176:191]
    v_mfma_f32_32x32x16_bf16 v[240:255], v[108:111], v[76:79], v[240:255]
    s_waitcnt lgkmcnt(0)
    v_mfma_f32_32x32x16_bf16 v[128:143], v[80:83], v[64:67], v[128:143]
    ds_read_b128 v[72:75], v2
    ds_read_b64_tr_b16 v[96:97], v5 offset:4096
    v_mfma_f32_32x32x16_bf16 v[192:207], v[80:83], v[68:71], v[192:207]
    ds_read_b64_tr_b16 v[98:99], v5 offset:5120
    ds_read_b128 v[76:79], v2 offset:4096
    v_mfma_f32_32x32x16_bf16 v[144:159], v[84:87], v[64:67], v[144:159]
    ds_read_b64_tr_b16 v[100:101], v6 offset:4096
    ds_read_b64_tr_b16 v[102:103], v6 offset:5120
    v_mfma_f32_32x32x16_bf16 v[208:223], v[84:87], v[68:71], v[208:223]
    ds_read_b64_tr_b16 v[104:105], v7 offset:4096
    ds_read_b64_tr_b16 v[106:107], v7 offset:5120
    v_mfma_f32_32x32x16_bf16 v[160:175], v[88:91], v[64:67], v[160:175]
    ds_read_b64_tr_b16 v[108:109], v8 offset:4096
    ds_read_b64_tr_b16 v[110:111], v8 offset:5120
    v_mfma_f32_32x32x16_bf16 v[224:239], v[88:91], v[68:71], v[224:239]
    v_mfma_f32_32x32x16_bf16 v[176:191], v[92:95], v[64:67], v[176:191]
    v_mfma_f32_32x32x16_bf16 v[240:255], v[92:95], v[68:71], v[240:255]
    s_waitcnt lgkmcnt(0)
    v_mfma_f32_32x32x16_bf16 v[128:143], v[96:99], v[72:75], v[128:143]
    ds_read_b128 v[64:67], v3
    ds_read_b64_tr_b16 v[80:81], v5 offset:8192
    v_mfma_f32_32x32x16_bf16 v[192:207], v[96:99], v[76:79], v[192:207]
    ds_read_b64_tr_b16 v[82:83], v5 offset:9216
    ds_read_b128 v[68:71], v3 offset:4096
    v_mfma_f32_32x32x16_bf16 v[144:159], v[100:103], v[72:75], v[144:159]
    ds_read_b64_tr_b16 v[84:85], v6 offset:8192
    ds_read_b64_tr_b16 v[86:87], v6 offset:9216
    v_mfma_f32_32x32x16_bf16 v[208:223], v[100:103], v[76:79], v[208:223]
    ds_read_b64_tr_b16 v[88:89], v7 offset:8192
    ds_read_b64_tr_b16 v[90:91], v7 offset:9216
    v_mfma_f32_32x32x16_bf16 v[160:175], v[104:107], v[72:75], v[160:175]
    ds_read_b64_tr_b16 v[92:93], v8 offset:8192
    ds_read_b64_tr_b16 v[94:95], v8 offset:9216
    v_mfma_f32_32x32x16_bf16 v[224:239], v[104:107], v[76:79], v[224:239]
    v_mfma_f32_32x32x16_bf16 v[176:191], v[108:111], v[72:75], v[176:191]
    v_mfma_f32_32x32x16_bf16 v[240:255], v[108:111], v[76:79], v[240:255]
    s_waitcnt lgkmcnt(0)
    v_mfma_f32_32x32x16_bf16 v[128:143], v[80:83], v[64:67], v[128:143]
    ds_read_b128 v[72:75], v4
    ds_read_b64_tr_b16 v[96:97], v5 offset:12288
    v_mfma_f32_32x32x16_bf16 v[192:207], v[80:83], v[68:71], v[192:207]
    ds_read_b64_tr_b16 v[98:99], v5 offset:13312
    ds_read_b128 v[76:79], v4 offset:4096
    v_mfma_f32_32x32x16_bf16 v[144:159], v[84:87], v[64:67], v[144:159]
    ds_read_b64_tr_b16 v[100:101], v6 offset:12288
    ds_read_b64_tr_b16 v[102:103], v6 offset:13312
    v_mfma_f32_32x32x16_bf16 v[208:223], v[84:87], v[68:71], v[208:223]
    ds_read_b64_tr_b16 v[104:105], v7 offset:12288
    ds_read_b64_tr_b16 v[106:107], v7 offset:13312
    v_mfma_f32_32x32x16_bf16 v[160:175], v[88:91], v[64:67], v[160:175]
    ds_read_b64_tr_b16 v[108:109], v8 offset:12288
    ds_read_b64_tr_b16 v[110:111], v8 offset:13312
    v_mfma_f32_32x32x16_bf16 v[224:239], v[88:91], v[68:71], v[224:239]
    v_mfma_f32_32x32x16_bf16 v[176:191], v[92:95], v[64:67], v[176:191]
    v_mfma_f32_32x32x16_bf16 v[240:255], v[92:95], v[68:71], v[240:255]
    s_waitcnt lgkmcnt(0)
    v_mfma_f32_32x32x16_bf16 v[128:143], v[96:99], v[72:75], v[128:143]
    s_barrier
    ds_read_b128 v[64:67], v9
    ds_read_b64_tr_b16 v[80:81], v13 offset:0
    v_mfma_f32_32x32x16_bf16 v[192:207], v[96:99], v[76:79], v[192:207]
    ds_read_b64_tr_b16 v[82:83], v13 offset:1024
    ds_read_b128 v[68:71], v9 offset:4096
    v_mfma_f32_32x32x16_bf16 v[144:159], v[100:103], v[72:75], v[144:159]
    ds_read_b64_tr_b16 v[84:85], v14 offset:0
    ds_read_b64_tr_b16 v[86:87], v14 offset:1024
    v_mfma_f32_32x32x16_bf16 v[208:223], v[100:103], v[76:79], v[208:223]
    ds_read_b64_tr_b16 v[88:89], v15 offset:0
    ds_read_b64_tr_b16 v[90:91], v15 offset:1024
    v_mfma_f32_32x32x16_bf16 v[160:175], v[104:107], v[72:75], v[160:175]
    ds_read_b64_tr_b16 v[92:93], v16 offset:0
    ds_read_b64_tr_b16 v[94:95], v16 offset:1024
    v_mfma_f32_32x32x16_bf16 v[224:239], v[104:107], v[76:79], v[224:239]
    v_mfma_f32_32x32x16_bf16 v[176:191], v[108:111], v[72:75], v[176:191]
    v_mfma_f32_32x32x16_bf16 v[240:255], v[108:111], v[76:79], v[240:255]
    s_waitcnt lgkmcnt(0)
    v_mfma_f32_32x32x16_bf16 v[128:143], v[80:83], v[64:67], v[128:143]
    ds_read_b128 v[72:75], v10
    ds_read_b64_tr_b16 v[96:97], v13 offset:4096
    v_mfma_f32_32x32x16_bf16 v[192:207], v[80:83], v[68:71], v[192:207]
    ds_read_b64_tr_b16 v[98:99], v13 offset:5120
    ds_read_b128 v[76:79], v10 offset:4096
    v_mfma_f32_32x32x16_bf16 v[144:159], v[84:87], v[64:67], v[144:159]
    ds_read_b64_tr_b16 v[100:101], v14 offset:4096
    ds_read_b64_tr_b16 v[102:103], v14 offset:5120
    v_mfma_f32_32x32x16_bf16 v[208:223], v[84:87], v[68:71], v[208:223]
    ds_read_b64_tr_b16 v[104:105], v15 offset:4096
    ds_read_b64_tr_b16 v[106:107], v15 offset:5120
    v_mfma_f32_32x32x16_bf16 v[160:175], v[88:91], v[64:67], v[160:175]
    ds_read_b64_tr_b16 v[108:109], v16 offset:4096
    ds_read_b64_tr_b16 v[110:111], v16 offset:5120
    v_mfma_f32_32x32x16_bf16 v[224:239], v[88:91], v[68:71], v[224:239]
    v_mfma_f32_32x32x16_bf16 v[176:191], v[92:95], v[64:67], v[176:191]
    v_mfma_f32_32x32x16_bf16 v[240:255], v[92:95], v[68:71], v[240:255]
    s_waitcnt lgkmcnt(0)
    v_mfma_f32_32x32x16_bf16 v[128:143], v[96:99], v[72:75], v[128:143]
    ds_read_b128 v[64:67], v11
    ds_read_b64_tr_b16 v[80:81], v13 offset:8192
    v_mfma_f32_32x32x16_bf16 v[192:207], v[96:99], v[76:79], v[192:207]
    ds_read_b64_tr_b16 v[82:83], v13 offset:9216
    ds_read_b128 v[68:71], v11 offset:4096
    v_mfma_f32_32x32x16_bf16 v[144:159], v[100:103], v[72:75], v[144:159]
    ds_read_b64_tr_b16 v[84:85], v14 offset:8192
    ds_read_b64_tr_b16 v[86:87], v14 offset:9216
    v_mfma_f32_32x32x16_bf16 v[208:223], v[100:103], v[76:79], v[208:223]
    ds_read_b64_tr_b16 v[88:89], v15 offset:8192
    ds_read_b64_tr_b16 v[90:91], v15 offset:9216
    v_mfma_f32_32x32x16_bf16 v[160:175], v[104:107], v[72:75], v[160:175]
    ds_read_b64_tr_b16 v[92:93], v16 offset:8192
    ds_read_b64_tr_b16 v[94:95], v16 offset:9216
    v_mfma_f32_32x32x16_bf16 v[224:239], v[104:107], v[76:79], v[224:239]
    v_mfma_f32_32x32x16_bf16 v[176:191], v[108:111], v[72:75], v[176:191]
    v_mfma_f32_32x32x16_bf16 v[240:255], v[108:111], v[76:79], v[240:255]
    s_waitcnt lgkmcnt(0)
    v_mfma_f32_32x32x16_bf16 v[128:143], v[80:83], v[64:67], v[128:143]
    ds_read_b128 v[72:75], v12
    ds_read_b64_tr_b16 v[96:97], v13 offset:12288
    v_mfma_f32_32x32x16_bf16 v[192:207], v[80:83], v[68:71], v[192:207]
    ds_read_b64_tr_b16 v[98:99], v13 offset:13312
    ds_read_b128 v[76:79], v12 offset:4096
    v_mfma_f32_32x32x16_bf16 v[144:159], v[84:87], v[64:67], v[144:159]
    ds_read_b64_tr_b16 v[100:101], v14 offset:12288
    ds_read_b64_tr_b16 v[102:103], v14 offset:13312
    v_mfma_f32_32x32x16_bf16 v[208:223], v[84:87], v[68:71], v[208:223]
    ds_read_b64_tr_b16 v[104:105], v15 offset:12288
    ds_read_b64_tr_b16 v[106:107], v15 offset:13312
    v_mfma_f32_32x32x16_bf16 v[160:175], v[88:91], v[64:67], v[160:175]
    ds_read_b64_tr_b16 v[108:109], v16 offset:12288
    ds_read_b64_tr_b16 v[110:111], v16 offset:13312
    v_mfma_f32_32x32x16_bf16 v[224:239], v[88:91], v[68:71], v[224:239]
    v_mfma_f32_32x32x16_bf16 v[176:191], v[92:95], v[64:67], v[176:191]
    v_mfma_f32_32x32x16_bf16 v[240:255], v[92:95], v[68:71], v[240:255]
    s_waitcnt lgkmcnt(0)
    v_mfma_f32_32x32x16_bf16 v[128:143], v[96:99], v[72:75], v[128:143]
    s_barrier
    ds_read_b128 v[64:67], v112
    ds_read_b64_tr_b16 v[80:81], v116 offset:0
    v_mfma_f32_32x32x16_bf16 v[192:207], v[96:99], v[76:79], v[192:207]
    ds_read_b64_tr_b16 v[82:83], v116 offset:1024
    ds_read_b128 v[68:71], v112 offset:4096
    v_mfma_f32_32x32x16_bf16 v[144:159], v[100:103], v[72:75], v[144:159]
    ds_read_b64_tr_b16 v[84:85], v117 offset:0
    ds_read_b64_tr_b16 v[86:87], v117 offset:1024
    v_mfma_f32_32x32x16_bf16 v[208:223], v[100:103], v[76:79], v[208:223]
    ds_read_b64_tr_b16 v[88:89], v118 offset:0
    ds_read_b64_tr_b16 v[90:91], v118 offset:1024
    v_mfma_f32_32x32x16_bf16 v[160:175], v[104:107], v[72:75], v[160:175]
    ds_read_b64_tr_b16 v[92:93], v119 offset:0
    ds_read_b64_tr_b16 v[94:95], v119 offset:1024
    v_mfma_f32_32x32x16_bf16 v[224:239], v[104:107], v[76:79], v[224:239]
    v_mfma_f32_32x32x16_bf16 v[176:191], v[108:111], v[72:75], v[176:191]
    v_mfma_f32_32x32x16_bf16 v[240:255], v[108:111], v[76:79], v[240:255]
    s_waitcnt lgkmcnt(0)
    v_mfma_f32_32x32x16_bf16 v[128:143], v[80:83], v[64:67], v[128:143]
    ds_read_b128 v[72:75], v113
    ds_read_b64_tr_b16 v[96:97], v116 offset:4096
    v_mfma_f32_32x32x16_bf16 v[192:207], v[80:83], v[68:71], v[192:207]
    ds_read_b64_tr_b16 v[98:99], v116 offset:5120
    ds_read_b128 v[76:79], v113 offset:4096
    v_mfma_f32_32x32x16_bf16 v[144:159], v[84:87], v[64:67], v[144:159]
    ds_read_b64_tr_b16 v[100:101], v117 offset:4096
    ds_read_b64_tr_b16 v[102:103], v117 offset:5120
    v_mfma_f32_32x32x16_bf16 v[208:223], v[84:87], v[68:71], v[208:223]
    ds_read_b64_tr_b16 v[104:105], v118 offset:4096
    ds_read_b64_tr_b16 v[106:107], v118 offset:5120
    v_mfma_f32_32x32x16_bf16 v[160:175], v[88:91], v[64:67], v[160:175]
    ds_read_b64_tr_b16 v[108:109], v119 offset:4096
    ds_read_b64_tr_b16 v[110:111], v119 offset:5120
    v_mfma_f32_32x32x16_bf16 v[224:239], v[88:91], v[68:71], v[224:239]
    v_mfma_f32_32x32x16_bf16 v[176:191], v[92:95], v[64:67], v[176:191]
    v_mfma_f32_32x32x16_bf16 v[240:255], v[92:95], v[68:71], v[240:255]
    s_waitcnt lgkmcnt(0)
    v_mfma_f32_32x32x16_bf16 v[128:143], v[96:99], v[72:75], v[128:143]
    ds_read_b128 v[64:67], v114
    ds_read_b64_tr_b16 v[80:81], v116 offset:8192
    v_mfma_f32_32x32x16_bf16 v[192:207], v[96:99], v[76:79], v[192:207]
    ds_read_b64_tr_b16 v[82:83], v116 offset:9216
    ds_read_b128 v[68:71], v114 offset:4096
    v_mfma_f32_32x32x16_bf16 v[144:159], v[100:103], v[72:75], v[144:159]
    ds_read_b64_tr_b16 v[84:85], v117 offset:8192
    ds_read_b64_tr_b16 v[86:87], v117 offset:9216
    v_mfma_f32_32x32x16_bf16 v[208:223], v[100:103], v[76:79], v[208:223]
    ds_read_b64_tr_b16 v[88:89], v118 offset:8192
    ds_read_b64_tr_b16 v[90:91], v118 offset:9216
    v_mfma_f32_32x32x16_bf16 v[160:175], v[104:107], v[72:75], v[160:175]
    ds_read_b64_tr_b16 v[92:93], v119 offset:8192
    ds_read_b64_tr_b16 v[94:95], v119 offset:9216
    v_mfma_f32_32x32x16_bf16 v[224:239], v[104:107], v[76:79], v[224:239]
    v_mfma_f32_32x32x16_bf16 v[176:191], v[108:111], v[72:75], v[176:191]
    v_mfma_f32_32x32x16_bf16 v[240:255], v[108:111], v[76:79], v[240:255]
    s_waitcnt lgkmcnt(0)
    v_mfma_f32_32x32x16_bf16 v[128:143], v[80:83], v[64:67], v[128:143]
    ds_read_b128 v[72:75], v115
    ds_read_b64_tr_b16 v[96:97], v116 offset:12288
    v_mfma_f32_32x32x16_bf16 v[192:207], v[80:83], v[68:71], v[192:207]
    ds_read_b64_tr_b16 v[98:99], v116 offset:13312
    ds_read_b128 v[76:79], v115 offset:4096
    v_mfma_f32_32x32x16_bf16 v[144:159], v[84:87], v[64:67], v[144:159]
    ds_read_b64_tr_b16 v[100:101], v117 offset:12288
    ds_read_b64_tr_b16 v[102:103], v117 offset:13312
    v_mfma_f32_32x32x16_bf16 v[208:223], v[84:87], v[68:71], v[208:223]
    ds_read_b64_tr_b16 v[104:105], v118 offset:12288
    ds_read_b64_tr_b16 v[106:107], v118 offset:13312
    v_mfma_f32_32x32x16_bf16 v[160:175], v[88:91], v[64:67], v[160:175]
    ds_read_b64_tr_b16 v[108:109], v119 offset:12288
    ds_read_b64_tr_b16 v[110:111], v119 offset:13312
    v_mfma_f32_32x32x16_bf16 v[224:239], v[88:91], v[68:71], v[224:239]
    v_mfma_f32_32x32x16_bf16 v[176:191], v[92:95], v[64:67], v[176:191]
    v_mfma_f32_32x32x16_bf16 v[240:255], v[92:95], v[68:71], v[240:255]
    s_waitcnt lgkmcnt(0)
    v_mfma_f32_32x32x16_bf16 v[128:143], v[96:99], v[72:75], v[128:143]
    s_barrier
    ds_read_b128 v[64:67], v1
    ds_read_b64_tr_b16 v[80:81], v5 offset:0
    v_mfma_f32_32x32x16_bf16 v[192:207], v[96:99], v[76:79], v[192:207]
    ds_read_b64_tr_b16 v[82:83], v5 offset:1024
    ds_read_b128 v[68:71], v1 offset:4096
    v_mfma_f32_32x32x16_bf16 v[144:159], v[100:103], v[72:75], v[144:159]
    ds_read_b64_tr_b16 v[84:85], v6 offset:0
    ds_read_b64_tr_b16 v[86:87], v6 offset:1024
    v_mfma_f32_32x32x16_bf16 v[208:223], v[100:103], v[76:79], v[208:223]
    ds_read_b64_tr_b16 v[88:89], v7 offset:0
    ds_read_b64_tr_b16 v[90:91], v7 offset:1024
    v_mfma_f32_32x32x16_bf16 v[160:175], v[104:107], v[72:75], v[160:175]
    ds_read_b64_tr_b16 v[92:93], v8 offset:0
    ds_read_b64_tr_b16 v[94:95], v8 offset:1024
    v_mfma_f32_32x32x16_bf16 v[224:239], v[104:107], v[76:79], v[224:239]
    v_mfma_f32_32x32x16_bf16 v[176:191], v[108:111], v[72:75], v[176:191]
    v_mfma_f32_32x32x16_bf16 v[240:255], v[108:111], v[76:79], v[240:255]
    s_waitcnt lgkmcnt(0)
    v_mfma_f32_32x32x16_bf16 v[128:143], v[80:83], v[64:67], v[128:143]
    ds_read_b128 v[72:75], v2
    ds_read_b64_tr_b16 v[96:97], v5 offset:4096
    v_mfma_f32_32x32x16_bf16 v[192:207], v[80:83], v[68:71], v[192:207]
    ds_read_b64_tr_b16 v[98:99], v5 offset:5120
    ds_read_b128 v[76:79], v2 offset:4096
    v_mfma_f32_32x32x16_bf16 v[144:159], v[84:87], v[64:67], v[144:159]
    ds_read_b64_tr_b16 v[100:101], v6 offset:4096
    ds_read_b64_tr_b16 v[102:103], v6 offset:5120
    v_mfma_f32_32x32x16_bf16 v[208:223], v[84:87], v[68:71], v[208:223]
    ds_read_b64_tr_b16 v[104:105], v7 offset:4096
    ds_read_b64_tr_b16 v[106:107], v7 offset:5120
    v_mfma_f32_32x32x16_bf16 v[160:175], v[88:91], v[64:67], v[160:175]
    ds_read_b64_tr_b16 v[108:109], v8 offset:4096
    ds_read_b64_tr_b16 v[110:111], v8 offset:5120
    v_mfma_f32_32x32x16_bf16 v[224:239], v[88:91], v[68:71], v[224:239]
    v_mfma_f32_32x32x16_bf16 v[176:191], v[92:95], v[64:67], v[176:191]
    v_mfma_f32_32x32x16_bf16 v[240:255], v[92:95], v[68:71], v[240:255]
    s_waitcnt lgkmcnt(0)
    v_mfma_f32_32x32x16_bf16 v[128:143], v[96:99], v[72:75], v[128:143]
    ds_read_b128 v[64:67], v3
    ds_read_b64_tr_b16 v[80:81], v5 offset:8192
    v_mfma_f32_32x32x16_bf16 v[192:207], v[96:99], v[76:79], v[192:207]
    ds_read_b64_tr_b16 v[82:83], v5 offset:9216
    ds_read_b128 v[68:71], v3 offset:4096
    v_mfma_f32_32x32x16_bf16 v[144:159], v[100:103], v[72:75], v[144:159]
    ds_read_b64_tr_b16 v[84:85], v6 offset:8192
    ds_read_b64_tr_b16 v[86:87], v6 offset:9216
    v_mfma_f32_32x32x16_bf16 v[208:223], v[100:103], v[76:79], v[208:223]
    ds_read_b64_tr_b16 v[88:89], v7 offset:8192
    ds_read_b64_tr_b16 v[90:91], v7 offset:9216
    v_mfma_f32_32x32x16_bf16 v[160:175], v[104:107], v[72:75], v[160:175]
    ds_read_b64_tr_b16 v[92:93], v8 offset:8192
    ds_read_b64_tr_b16 v[94:95], v8 offset:9216
    v_mfma_f32_32x32x16_bf16 v[224:239], v[104:107], v[76:79], v[224:239]
    v_mfma_f32_32x32x16_bf16 v[176:191], v[108:111], v[72:75], v[176:191]
    v_mfma_f32_32x32x16_bf16 v[240:255], v[108:111], v[76:79], v[240:255]
    s_waitcnt lgkmcnt(0)
    v_mfma_f32_32x32x16_bf16 v[128:143], v[80:83], v[64:67], v[128:143]
    ds_read_b128 v[72:75], v4
    ds_read_b64_tr_b16 v[96:97], v5 offset:12288
    v_mfma_f32_32x32x16_bf16 v[192:207], v[80:83], v[68:71], v[192:207]
    ds_read_b64_tr_b16 v[98:99], v5 offset:13312
    ds_read_b128 v[76:79], v4 offset:4096
    v_mfma_f32_32x32x16_bf16 v[144:159], v[84:87], v[64:67], v[144:159]
    ds_read_b64_tr_b16 v[100:101], v6 offset:12288
    ds_read_b64_tr_b16 v[102:103], v6 offset:13312
    v_mfma_f32_32x32x16_bf16 v[208:223], v[84:87], v[68:71], v[208:223]
    ds_read_b64_tr_b16 v[104:105], v7 offset:12288
    ds_read_b64_tr_b16 v[106:107], v7 offset:13312
    v_mfma_f32_32x32x16_bf16 v[160:175], v[88:91], v[64:67], v[160:175]
    ds_read_b64_tr_b16 v[108:109], v8 offset:12288
    ds_read_b64_tr_b16 v[110:111], v8 offset:13312
    v_mfma_f32_32x32x16_bf16 v[224:239], v[88:91], v[68:71], v[224:239]
    v_mfma_f32_32x32x16_bf16 v[176:191], v[92:95], v[64:67], v[176:191]
    v_mfma_f32_32x32x16_bf16 v[240:255], v[92:95], v[68:71], v[240:255]
    s_waitcnt lgkmcnt(0)
    v_mfma_f32_32x32x16_bf16 v[128:143], v[96:99], v[72:75], v[128:143]
    s_barrier
    ds_read_b128 v[64:67], v9
    ds_read_b64_tr_b16 v[80:81], v13 offset:0
    v_mfma_f32_32x32x16_bf16 v[192:207], v[96:99], v[76:79], v[192:207]
    ds_read_b64_tr_b16 v[82:83], v13 offset:1024
    ds_read_b128 v[68:71], v9 offset:4096
    v_mfma_f32_32x32x16_bf16 v[144:159], v[100:103], v[72:75], v[144:159]
    ds_read_b64_tr_b16 v[84:85], v14 offset:0
    ds_read_b64_tr_b16 v[86:87], v14 offset:1024
    v_mfma_f32_32x32x16_bf16 v[208:223], v[100:103], v[76:79], v[208:223]
    ds_read_b64_tr_b16 v[88:89], v15 offset:0
    ds_read_b64_tr_b16 v[90:91], v15 offset:1024
    v_mfma_f32_32x32x16_bf16 v[160:175], v[104:107], v[72:75], v[160:175]
    ds_read_b64_tr_b16 v[92:93], v16 offset:0
    ds_read_b64_tr_b16 v[94:95], v16 offset:1024
    v_mfma_f32_32x32x16_bf16 v[224:239], v[104:107], v[76:79], v[224:239]
    v_mfma_f32_32x32x16_bf16 v[176:191], v[108:111], v[72:75], v[176:191]
    v_mfma_f32_32x32x16_bf16 v[240:255], v[108:111], v[76:79], v[240:255]
    s_waitcnt lgkmcnt(0)
    v_mfma_f32_32x32x16_bf16 v[128:143], v[80:83], v[64:67], v[128:143]
    ds_read_b128 v[72:75], v10
    ds_read_b64_tr_b16 v[96:97], v13 offset:4096
    v_mfma_f32_32x32x16_bf16 v[192:207], v[80:83], v[68:71], v[192:207]
    ds_read_b64_tr_b16 v[98:99], v13 offset:5120
    ds_read_b128 v[76:79], v10 offset:4096
    v_mfma_f32_32x32x16_bf16 v[144:159], v[84:87], v[64:67], v[144:159]
    ds_read_b64_tr_b16 v[100:101], v14 offset:4096
    ds_read_b64_tr_b16 v[102:103], v14 offset:5120
    v_mfma_f32_32x32x16_bf16 v[208:223], v[84:87], v[68:71], v[208:223]
    ds_read_b64_tr_b16 v[104:105], v15 offset:4096
    ds_read_b64_tr_b16 v[106:107], v15 offset:5120
    v_mfma_f32_32x32x16_bf16 v[160:175], v[88:91], v[64:67], v[160:175]
    ds_read_b64_tr_b16 v[108:109], v16 offset:4096
    ds_read_b64_tr_b16 v[110:111], v16 offset:5120
    v_mfma_f32_32x32x16_bf16 v[224:239], v[88:91], v[68:71], v[224:239]
    v_mfma_f32_32x32x16_bf16 v[176:191], v[92:95], v[64:67], v[176:191]
    v_mfma_f32_32x32x16_bf16 v[240:255], v[92:95], v[68:71], v[240:255]
    s_waitcnt lgkmcnt(0)
    v_mfma_f32_32x32x16_bf16 v[128:143], v[96:99], v[72:75], v[128:143]
    ds_read_b128 v[64:67], v11
    ds_read_b64_tr_b16 v[80:81], v13 offset:8192
    v_mfma_f32_32x32x16_bf16 v[192:207], v[96:99], v[76:79], v[192:207]
    ds_read_b64_tr_b16 v[82:83], v13 offset:9216
    ds_read_b128 v[68:71], v11 offset:4096
    v_mfma_f32_32x32x16_bf16 v[144:159], v[100:103], v[72:75], v[144:159]
    ds_read_b64_tr_b16 v[84:85], v14 offset:8192
    ds_read_b64_tr_b16 v[86:87], v14 offset:9216
    v_mfma_f32_32x32x16_bf16 v[208:223], v[100:103], v[76:79], v[208:223]
    ds_read_b64_tr_b16 v[88:89], v15 offset:8192
    ds_read_b64_tr_b16 v[90:91], v15 offset:9216
    v_mfma_f32_32x32x16_bf16 v[160:175], v[104:107], v[72:75], v[160:175]
    ds_read_b64_tr_b16 v[92:93], v16 offset:8192
    ds_read_b64_tr_b16 v[94:95], v16 offset:9216
    v_mfma_f32_32x32x16_bf16 v[224:239], v[104:107], v[76:79], v[224:239]
    v_mfma_f32_32x32x16_bf16 v[176:191], v[108:111], v[72:75], v[176:191]
    v_mfma_f32_32x32x16_bf16 v[240:255], v[108:111], v[76:79], v[240:255]
    s_waitcnt lgkmcnt(0)
    v_mfma_f32_32x32x16_bf16 v[128:143], v[80:83], v[64:67], v[128:143]
    ds_read_b128 v[72:75], v12
    ds_read_b64_tr_b16 v[96:97], v13 offset:12288
    v_mfma_f32_32x32x16_bf16 v[192:207], v[80:83], v[68:71], v[192:207]
    ds_read_b64_tr_b16 v[98:99], v13 offset:13312
    ds_read_b128 v[76:79], v12 offset:4096
    v_mfma_f32_32x32x16_bf16 v[144:159], v[84:87], v[64:67], v[144:159]
    ds_read_b64_tr_b16 v[100:101], v14 offset:12288
    ds_read_b64_tr_b16 v[102:103], v14 offset:13312
    v_mfma_f32_32x32x16_bf16 v[208:223], v[84:87], v[68:71], v[208:223]
    ds_read_b64_tr_b16 v[104:105], v15 offset:12288
    ds_read_b64_tr_b16 v[106:107], v15 offset:13312
    v_mfma_f32_32x32x16_bf16 v[160:175], v[88:91], v[64:67], v[160:175]
    ds_read_b64_tr_b16 v[108:109], v16 offset:12288
    ds_read_b64_tr_b16 v[110:111], v16 offset:13312
    v_mfma_f32_32x32x16_bf16 v[224:239], v[88:91], v[68:71], v[224:239]
    v_mfma_f32_32x32x16_bf16 v[176:191], v[92:95], v[64:67], v[176:191]
    v_mfma_f32_32x32x16_bf16 v[240:255], v[92:95], v[68:71], v[240:255]
    s_waitcnt lgkmcnt(0)
    v_mfma_f32_32x32x16_bf16 v[128:143], v[96:99], v[72:75], v[128:143]
    s_barrier
    ds_read_b128 v[64:67], v112
    ds_read_b64_tr_b16 v[80:81], v116 offset:0
    v_mfma_f32_32x32x16_bf16 v[192:207], v[96:99], v[76:79], v[192:207]
    ds_read_b64_tr_b16 v[82:83], v116 offset:1024
    ds_read_b128 v[68:71], v112 offset:4096
    v_mfma_f32_32x32x16_bf16 v[144:159], v[100:103], v[72:75], v[144:159]
    ds_read_b64_tr_b16 v[84:85], v117 offset:0
    ds_read_b64_tr_b16 v[86:87], v117 offset:1024
    v_mfma_f32_32x32x16_bf16 v[208:223], v[100:103], v[76:79], v[208:223]
    ds_read_b64_tr_b16 v[88:89], v118 offset:0
    ds_read_b64_tr_b16 v[90:91], v118 offset:1024
    v_mfma_f32_32x32x16_bf16 v[160:175], v[104:107], v[72:75], v[160:175]
    ds_read_b64_tr_b16 v[92:93], v119 offset:0
    ds_read_b64_tr_b16 v[94:95], v119 offset:1024
    v_mfma_f32_32x32x16_bf16 v[224:239], v[104:107], v[76:79], v[224:239]
    v_mfma_f32_32x32x16_bf16 v[176:191], v[108:111], v[72:75], v[176:191]
    v_mfma_f32_32x32x16_bf16 v[240:255], v[108:111], v[76:79], v[240:255]
    s_waitcnt lgkmcnt(0)
    v_mfma_f32_32x32x16_bf16 v[128:143], v[80:83], v[64:67], v[128:143]
    ds_read_b128 v[72:75], v113
    ds_read_b64_tr_b16 v[96:97], v116 offset:4096
    v_mfma_f32_32x32x16_bf16 v[192:207], v[80:83], v[68:71], v[192:207]
    ds_read_b64_tr_b16 v[98:99], v116 offset:5120
    ds_read_b128 v[76:79], v113 offset:4096
    v_mfma_f32_32x32x16_bf16 v[144:159], v[84:87], v[64:67], v[144:159]
    ds_read_b64_tr_b16 v[100:101], v117 offset:4096
    ds_read_b64_tr_b16 v[102:103], v117 offset:5120
    v_mfma_f32_32x32x16_bf16 v[208:223], v[84:87], v[68:71], v[208:223]
    ds_read_b64_tr_b16 v[104:105], v118 offset:4096
    ds_read_b64_tr_b16 v[106:107], v118 offset:5120
    v_mfma_f32_32x32x16_bf16 v[160:175], v[88:91], v[64:67], v[160:175]
    ds_read_b64_tr_b16 v[108:109], v119 offset:4096
    ds_read_b64_tr_b16 v[110:111], v119 offset:5120
    v_mfma_f32_32x32x16_bf16 v[224:239], v[88:91], v[68:71], v[224:239]
    v_mfma_f32_32x32x16_bf16 v[176:191], v[92:95], v[64:67], v[176:191]
    v_mfma_f32_32x32x16_bf16 v[240:255], v[92:95], v[68:71], v[240:255]
    s_waitcnt lgkmcnt(0)
    v_mfma_f32_32x32x16_bf16 v[128:143], v[96:99], v[72:75], v[128:143]
    ds_read_b128 v[64:67], v114
    ds_read_b64_tr_b16 v[80:81], v116 offset:8192
    v_mfma_f32_32x32x16_bf16 v[192:207], v[96:99], v[76:79], v[192:207]
    ds_read_b64_tr_b16 v[82:83], v116 offset:9216
    ds_read_b128 v[68:71], v114 offset:4096
    v_mfma_f32_32x32x16_bf16 v[144:159], v[100:103], v[72:75], v[144:159]
    ds_read_b64_tr_b16 v[84:85], v117 offset:8192
    ds_read_b64_tr_b16 v[86:87], v117 offset:9216
    v_mfma_f32_32x32x16_bf16 v[208:223], v[100:103], v[76:79], v[208:223]
    ds_read_b64_tr_b16 v[88:89], v118 offset:8192
    ds_read_b64_tr_b16 v[90:91], v118 offset:9216
    v_mfma_f32_32x32x16_bf16 v[160:175], v[104:107], v[72:75], v[160:175]
    ds_read_b64_tr_b16 v[92:93], v119 offset:8192
    ds_read_b64_tr_b16 v[94:95], v119 offset:9216
    s_mov_b32 m0, s17
    s_add_u32 s17, s17, 8192
    buffer_load_dwordx4 v32, s[20:23], s16 offen lds
    buffer_load_dwordx4 v33, s[20:23], s16 offen offset:1024 lds
    s_add_u32 s16, s16, 14336
    s_mov_b32 m0, s17
    s_add_u32 s17, s17, 8192
    buffer_load_dwordx4 v32, s[20:23], s16 offen lds
    buffer_load_dwordx4 v33, s[20:23], s16 offen offset:1024 lds
    s_add_u32 s16, s16, 14336
    v_mfma_f32_32x32x16_bf16 v[224:239], v[104:107], v[76:79], v[224:239]
    v_mfma_f32_32x32x16_bf16 v[176:191], v[108:111], v[72:75], v[176:191]
    v_mfma_f32_32x32x16_bf16 v[240:255], v[108:111], v[76:79], v[240:255]
    s_waitcnt lgkmcnt(0)
    v_mfma_f32_32x32x16_bf16 v[128:143], v[80:83], v[64:67], v[128:143]
    ds_read_b128 v[72:75], v115
    ds_read_b64_tr_b16 v[96:97], v116 offset:12288
    v_mfma_f32_32x32x16_bf16 v[192:207], v[80:83], v[68:71], v[192:207]
    ds_read_b64_tr_b16 v[98:99], v116 offset:13312
    ds_read_b128 v[76:79], v115 offset:4096
    v_mfma_f32_32x32x16_bf16 v[144:159], v[84:87], v[64:67], v[144:159]
    ds_read_b64_tr_b16 v[100:101], v117 offset:12288
    ds_read_b64_tr_b16 v[102:103], v117 offset:13312
    v_mfma_f32_32x32x16_bf16 v[208:223], v[84:87], v[68:71], v[208:223]
    ds_read_b64_tr_b16 v[104:105], v118 offset:12288
    ds_read_b64_tr_b16 v[106:107], v118 offset:13312
    v_mfma_f32_32x32x16_bf16 v[160:175], v[88:91], v[64:67], v[160:175]
    ds_read_b64_tr_b16 v[108:109], v119 offset:12288
    ds_read_b64_tr_b16 v[110:111], v119 offset:13312
    s_mov_b32 m0, s17
    s_add_u32 s17, s17, 8192
    buffer_load_dwordx4 v32, s[20:23], s16 offen lds
    buffer_load_dwordx4 v33, s[20:23], s16 offen offset:1024 lds
    s_add_u32 s16, s16, 14336
    s_mov_b32 m0, s17
    s_add_u32 s17, s17, 8192
    buffer_load_dwordx4 v32, s[20:23], s16 offen lds
    buffer_load_dwordx4 v33, s[20:23], s16 offen offset:1024 lds
    s_add_u32 s16, s16, 14336
    v_mfma_f32_32x32x16_bf16 v[224:239], v[88:91], v[68:71], v[224:239]
    v_mfma_f32_32x32x16_bf16 v[176:191], v[92:95], v[64:67], v[176:191]
    v_mfma_f32_32x32x16_bf16 v[240:255], v[92:95], v[68:71], v[240:255]
    s_waitcnt lgkmcnt(0)
    s_setprio 3
    v_mfma_f32_32x32x16_bf16 v[128:143], v[96:99], v[72:75], v[128:143]
    v_mfma_f32_32x32x16_bf16 v[192:207], v[96:99], v[76:79], v[192:207]
    s_nop 10
    v_mul_f32 v128, v128, v136
    v_mul_f32 v129, v129, v137
    v_mul_f32 v130, v130, v138
    v_mul_f32 v131, v131, v139
    v_mul_f32 v132, v132, v140
    v_mul_f32 v133, v133, v141
    v_mul_f32 v134, v134, v142
    v_mul_f32 v135, v135, v143
    v_cvt_pk_bf16_f32 v136, v128, v129
    v_cvt_pk_bf16_f32 v137, v130, v131
    v_cvt_pk_bf16_f32 v138, v132, v133
    v_cvt_pk_bf16_f32 v139, v134, v135
    buffer_store_dwordx4 v[136:139], v29, s[28:31], s56 offen offset:0 sc1
    v_mfma_f32_32x32x16_bf16 v[144:159], v[100:103], v[72:75], v[144:159]
    v_mul_f32 v192, v192, v200
    v_mul_f32 v193, v193, v201
    v_mul_f32 v194, v194, v202
    v_mul_f32 v195, v195, v203
    v_mul_f32 v196, v196, v204
    v_mul_f32 v197, v197, v205
    v_mul_f32 v198, v198, v206
    v_mul_f32 v199, v199, v207
    v_cvt_pk_bf16_f32 v200, v192, v193
    v_cvt_pk_bf16_f32 v201, v194, v195
    v_cvt_pk_bf16_f32 v202, v196, v197
    v_cvt_pk_bf16_f32 v203, v198, v199
    buffer_store_dwordx4 v[200:203], v29, s[28:31], s57 offen offset:0 sc1
    v_mfma_f32_32x32x16_bf16 v[208:223], v[100:103], v[76:79], v[208:223]
    v_mul_f32 v144, v144, v152
    v_mul_f32 v145, v145, v153
    v_mul_f32 v146, v146, v154
    v_mul_f32 v147, v147, v155
    v_mul_f32 v148, v148, v156
    v_mul_f32 v149, v149, v157
    v_mul_f32 v150, v150, v158
    v_mul_f32 v151, v151, v159
    v_cvt_pk_bf16_f32 v152, v144, v145
    v_cvt_pk_bf16_f32 v153, v146, v147
    v_cvt_pk_bf16_f32 v154, v148, v149
    v_cvt_pk_bf16_f32 v155, v150, v151
    buffer_store_dwordx4 v[152:155], v29, s[28:31], s56 offen offset:1024 sc1
    v_mfma_f32_32x32x16_bf16 v[160:175], v[104:107], v[72:75], v[160:175]
    v_mul_f32 v208, v208, v216
    v_mul_f32 v209, v209, v217
    v_mul_f32 v210, v210, v218
    v_mul_f32 v211, v211, v219
    v_mul_f32 v212, v212, v220
    v_mul_f32 v213, v213, v221
    v_mul_f32 v214, v214, v222
    v_mul_f32 v215, v215, v223
    v_cvt_pk_bf16_f32 v216, v208, v209
    v_cvt_pk_bf16_f32 v217, v210, v211
    v_cvt_pk_bf16_f32 v218, v212, v213
    v_cvt_pk_bf16_f32 v219, v214, v215
    buffer_store_dwordx4 v[216:219], v29, s[28:31], s57 offen offset:1024 sc1
    v_mfma_f32_32x32x16_bf16 v[224:239], v[104:107], v[76:79], v[224:239]
    v_mul_f32 v160, v160, v168
    v_mul_f32 v161, v161, v169
    v_mul_f32 v162, v162, v170
    v_mul_f32 v163, v163, v171
    v_mul_f32 v164, v164, v172
    v_mul_f32 v165, v165, v173
    v_mul_f32 v166, v166, v174
    v_mul_f32 v167, v167, v175
    v_cvt_pk_bf16_f32 v168, v160, v161
    v_cvt_pk_bf16_f32 v169, v162, v163
    v_cvt_pk_bf16_f32 v170, v164, v165
    v_cvt_pk_bf16_f32 v171, v166, v167
    buffer_store_dwordx4 v[168:171], v29, s[28:31], s56 offen offset:2048 sc1
    v_mfma_f32_32x32x16_bf16 v[176:191], v[108:111], v[72:75], v[176:191]
    v_mul_f32 v224, v224, v232
    v_mul_f32 v225, v225, v233
    v_mul_f32 v226, v226, v234
    v_mul_f32 v227, v227, v235
    v_mul_f32 v228, v228, v236
    v_mul_f32 v229, v229, v237
    v_mul_f32 v230, v230, v238
    v_mul_f32 v231, v231, v239
    v_cvt_pk_bf16_f32 v232, v224, v225
    v_cvt_pk_bf16_f32 v233, v226, v227
    v_cvt_pk_bf16_f32 v234, v228, v229
    v_cvt_pk_bf16_f32 v235, v230, v231
    buffer_store_dwordx4 v[232:235], v29, s[28:31], s57 offen offset:2048 sc1
    v_mfma_f32_32x32x16_bf16 v[240:255], v[108:111], v[76:79], v[240:255]
    v_mul_f32 v176, v176, v184
    v_mul_f32 v177, v177, v185
    v_mul_f32 v178, v178, v186
    v_mul_f32 v179, v179, v187
    v_mul_f32 v180, v180, v188
    v_mul_f32 v181, v181, v189
    v_mul_f32 v182, v182, v190
    v_mul_f32 v183, v183, v191
    v_cvt_pk_bf16_f32 v184, v176, v177
    v_cvt_pk_bf16_f32 v185, v178, v179
    v_cvt_pk_bf16_f32 v186, v180, v181
    v_cvt_pk_bf16_f32 v187, v182, v183
    buffer_store_dwordx4 v[184:187], v29, s[28:31], s56 offen offset:3072 sc1
    v_mul_f32 v240, v240, v248
    v_mul_f32 v241, v241, v249
    v_mul_f32 v242, v242, v250
    v_mul_f32 v243, v243, v251
    v_mul_f32 v244, v244, v252
    v_mul_f32 v245, v245, v253
    v_mul_f32 v246, v246, v254
    v_mul_f32 v247, v247, v255
    v_cvt_pk_bf16_f32 v248, v240, v241
    v_cvt_pk_bf16_f32 v249, v242, v243
    v_cvt_pk_bf16_f32 v250, v244, v245
    v_cvt_pk_bf16_f32 v251, v246, v247
    buffer_store_dwordx4 v[248:251], v29, s[28:31], s57 offen offset:3072 sc1
    s_mov_b32 s19, 8
    s_setprio 3
    s_mov_b32 s62, 1048576
L_g_gof:
    ds_read_b32 v24, v25 offset:4
    s_waitcnt lgkmcnt(0)
    v_readfirstlane_b32 s63, v24
    s_sub_u32 s62, s62, 1
    s_cmp_eq_u32 s62, 0
    s_cbranch_scc1 L_g_gof_x
    s_cmp_ge_u32 s63, 1
    s_cbranch_scc1 L_g_gof_x
    s_sleep 2
    s_branch L_g_gof
L_g_gof_x:
    s_waitcnt vmcnt(0)
    s_mov_b64 exec, 1
    ds_add_rtn_u32 v24, v25, v26 offset:8
    s_waitcnt lgkmcnt(0)
    v_readfirstlane_b32 s63, v24
    s_lshl_b32 s70, s46, 4
    s_add_u32 s70, s70, s47
    s_lshl_b32 s70, s70, 7
    s_add_u32 s70, s70, 294912
    s_cmp_lg_u32 s63, 3
    s_cbranch_scc1 L_g_nosigf
    buffer_store_dword v26, off, s[28:31], s70 sc1
L_g_nosigf:
    s_mov_b64 exec, -1
L_gd:
    s_setprio 0
    s_waitcnt vmcnt(6)
    s_mov_b32 m0, s17
    s_add_u32 s17, s17, 8192
    buffer_load_dwordx4 v32, s[20:23], s16 offen lds
    buffer_load_dwordx4 v33, s[20:23], s16 offen offset:1024 lds
    s_add_u32 s16, s16, 14336
    s_waitcnt vmcnt(6)
    s_mov_b32 m0, s17
    s_add_u32 s17, s17, 8192
    buffer_load_dwordx4 v32, s[20:23], s16 offen lds
    buffer_load_dwordx4 v33, s[20:23], s16 offen offset:1024 lds
    s_add_u32 s16, s16, 14336
    s_waitcnt vmcnt(6)
    s_mov_b32 m0, s17
    s_add_u32 s17, s17, 8192
    buffer_load_dwordx4 v32, s[20:23], s16 offen lds
    buffer_load_dwordx4 v33, s[20:23], s16 offen offset:1024 lds
    s_add_u32 s16, s16, 14336
    s_waitcnt vmcnt(6)
    s_mov_b32 m0, s17
    s_add_u32 s17, s17, 8192
    buffer_load_dwordx4 v32, s[20:23], s16 offen lds
    buffer_load_dwordx4 v33, s[20:23], s16 offen offset:1024 lds
    s_add_u32 s16, s16, 14336
    s_waitcnt vmcnt(6)
    s_mov_b32 m0, s17
    s_add_u32 s17, s17, 8192
    buffer_load_dwordx4 v32, s[20:23], s16 offen lds
    buffer_load_dwordx4 v33, s[20:23], s16 offen offset:1024 lds
    s_add_u32 s16, s16, 14336
    s_waitcnt vmcnt(6)
    s_mov_b32 m0, s17
    s_add_u32 s17, s17, 8192
    buffer_load_dwordx4 v32, s[20:23], s16 offen lds
    buffer_load_dwordx4 v33, s[20:23], s16 offen offset:1024 lds
    s_add_u32 s16, s16, 14336
    s_waitcnt vmcnt(6)
    s_mov_b32 m0, s17
    s_add_u32 s17, s17, 8192
    buffer_load_dwordx4 v32, s[20:23], s16 offen lds
    buffer_load_dwordx4 v33, s[20:23], s16 offen offset:1024 lds
    s_add_u32 s16, s16, 14336
    s_waitcnt vmcnt(6)
    s_mov_b32 m0, s17
    s_add_u32 s17, s17, 8192
    buffer_load_dwordx4 v32, s[20:23], s16 offen lds
    buffer_load_dwordx4 v33, s[20:23], s16 offen offset:1024 lds
    s_add_u32 s16, s16, 14336
    s_setprio 3
    s_mov_b32 s62, 1048576
L_gd_s1:
    ds_read_b32 v24, v25 offset:28
    s_waitcnt lgkmcnt(0)
    v_readfirstlane_b32 s63, v24
    s_sub_u32 s62, s62, 1
    s_cmp_eq_u32 s62, 0
    s_cbranch_scc1 L_gd_s1_x
    s_cmp_ge_u32 s63, 4
    s_cbranch_scc1 L_gd_s1_x
    s_sleep 2
    s_branch L_gd_s1
L_gd_s1_x:
    s_mov_b32 s62, 1048576
L_gd_s2:
    ds_read_b32 v24, v25 offset:8
    s_waitcnt lgkmcnt(0)
    v_readfirstlane_b32 s63, v24
    s_sub_u32 s62, s62, 1
    s_cmp_eq_u32 s62, 0
    s_cbranch_scc1 L_gd_s2_x
    s_cmp_ge_u32 s63, 4
    s_cbranch_scc1 L_gd_s2_x
    s_sleep 2
    s_branch L_gd_s2
L_gd_s2_x:
    s_mov_b32 m0, s17
    s_add_u32 s17, s17, 8192
    buffer_load_dwordx4 v32, s[20:23], s16 offen lds
    buffer_load_dwordx4 v33, s[20:23], s16 offen offset:1024 lds
    s_add_u32 s16, s16, 14336
    s_mov_b32 m0, s17
    s_add_u32 s17, s17, 8192
    buffer_load_dwordx4 v32, s[20:23], s16 offen lds
    buffer_load_dwordx4 v33, s[20:23], s16 offen offset:1024 lds
    s_add_u32 s16, s16, 14336
    s_lshl_b32 s70, s11, 7
    s_add_u32 s70, s70, 262144
    buffer_load_dword v9, v42, s[28:31], s70 offen sc1
    s_lshr_b32 s70, s48, 1
    s_lshl_b32 s70, s70, 11
    s_add_u32 s70, s70, 294912
    s_setprio 3
    s_mov_b32 s62, 131072
    s_mov_b32 s19, 0
L_gd_poll:
    buffer_load_dword v18, v43, s[28:31], s70 offen sc1
    s_waitcnt vmcnt(0)
L_gd_p1:
    v_cmp_ne_u32 vcc, 1, v18
    s_sub_u32 s62, s62, 1
    s_cmp_eq_u32 s62, 0
    s_cbranch_scc1 L_gd_go
    s_cbranch_vccz L_gd_go
    s_sleep 2
    s_branch L_gd_poll
L_gd_go:
    s_setprio 0
    s_mul_i32 s59, s13, 14336
    buffer_load_dwordx4 v[64:67], v40, s[28:31], s59 offen offset:0 sc1
    buffer_load_dwordx4 v[68:71], v41, s[28:31], s59 offen offset:0 sc1
    buffer_load_dwordx4 v[72:75], v40, s[28:31], s59 offen offset:1024 sc1
    buffer_load_dwordx4 v[76:79], v41, s[28:31], s59 offen offset:1024 sc1
    buffer_load_dwordx4 v[80:83], v40, s[28:31], s59 offen offset:2048 sc1
    buffer_load_dwordx4 v[84:87], v41, s[28:31], s59 offen offset:2048 sc1
    s_mul_i32 s16, s14, 200704
    s_add_u32 s16, s16, s15
    ds_read_b64_tr_b16 v[176:177], v34 offset:0
    ds_read_b64_tr_b16 v[178:179], v34 offset:1024
    ds_read_b64_tr_b16 v[180:181], v35 offset:0
    ds_read_b64_tr_b16 v[182:183], v35 offset:1024
    s_waitcnt vmcnt(4) lgkmcnt(0)
    v_mfma_f32_32x32x16_bf16 v[192:207], v[176:179], v[64:67], 0
    ds_read_b64_tr_b16 v[184:185], v34 offset:8192
    v_mfma_f32_32x32x16_bf16 v[208:223], v[180:183], v[64:67], 0
    ds_read_b64_tr_b16 v[186:187], v34 offset:9216
    buffer_load_dwordx4 v[88:91], v40, s[28:31], s59 offen offset:3072 sc1
    buffer_load_dwordx4 v[92:95], v41, s[28:31], s59 offen offset:3072 sc1
    s_add_u32 s59, s59, 4096
    v_mfma_f32_32x32x16_bf16 v[224:239], v[176:179], v[68:71], 0
    ds_read_b64_tr_b16 v[188:189], v35 offset:8192
    v_mfma_f32_32x32x16_bf16 v[240:255], v[180:183], v[68:71], 0
    ds_read_b64_tr_b16 v[190:191], v35 offset:9216
    s_add_u32 m0, s12, 0
    s_nop 0
    buffer_load_dwordx4 v32, s[20:23], s16 offen lds
    buffer_load_dwordx4 v33, s[20:23], s16 offen offset:1024 lds
    s_add_u32 s16, s16, 14336
    s_waitcnt vmcnt(6) lgkmcnt(0)
    v_mfma_f32_32x32x16_bf16 v[192:207], v[184:187], v[72:75], v[192:207]
    ds_read_b64_tr_b16 v[176:177], v34 offset:16384
    v_mfma_f32_32x32x16_bf16 v[208:223], v[188:191], v[72:75], v[208:223]
    ds_read_b64_tr_b16 v[178:179], v34 offset:17408
    buffer_load_dwordx4 v[64:67], v40, s[28:31], s59 offen offset:0 sc1
    buffer_load_dwordx4 v[68:71], v41, s[28:31], s59 offen offset:0 sc1
    v_mfma_f32_32x32x16_bf16 v[224:239], v[184:187], v[76:79], v[224:239]
    ds_read_b64_tr_b16 v[180:181], v35 offset:16384
    v_mfma_f32_32x32x16_bf16 v[240:255], v[188:191], v[76:79], v[240:255]
    ds_read_b64_tr_b16 v[182:183], v35 offset:17408
    s_add_u32 m0, s12, 8192
    s_nop 0
    buffer_load_dwordx4 v32, s[20:23], s16 offen lds
    buffer_load_dwordx4 v33, s[20:23], s16 offen offset:1024 lds
    s_add_u32 s16, s16, 14336
    s_waitcnt vmcnt(8) lgkmcnt(0)
    v_mfma_f32_32x32x16_bf16 v[192:207], v[176:179], v[80:83], v[192:207]
    ds_read_b64_tr_b16 v[184:185], v34 offset:24576
    v_mfma_f32_32x32x16_bf16 v[208:223], v[180:183], v[80:83], v[208:223]
    ds_read_b64_tr_b16 v[186:187], v34 offset:25600
    buffer_load_dwordx4 v[72:75], v40, s[28:31], s59 offen offset:1024 sc1
    buffer_load_dwordx4 v[76:79], v41, s[28:31], s59 offen offset:1024 sc1
    v_mfma_f32_32x32x16_bf16 v[224:239], v[176:179], v[84:87], v[224:239]
    ds_read_b64_tr_b16 v[188:189], v35 offset:24576
    v_mfma_f32_32x32x16_bf16 v[240:255], v[180:183], v[84:87], v[240:255]
    ds_read_b64_tr_b16 v[190:191], v35 offset:25600
    s_add_u32 m0, s12, 16384
    s_nop 0
    buffer_load_dwordx4 v32, s[20:23], s16 offen lds
    buffer_load_dwordx4 v33, s[20:23], s16 offen offset:1024 lds
    s_add_u32 s16, s16, 14336
    s_waitcnt vmcnt(10) lgkmcnt(0)
    v_mfma_f32_32x32x16_bf16 v[192:207], v[184:187], v[88:91], v[192:207]
    ds_read_b64_tr_b16 v[176:177], v34 offset:32768
    v_mfma_f32_32x32x16_bf16 v[208:223], v[188:191], v[88:91], v[208:223]
    ds_read_b64_tr_b16 v[178:179], v34 offset:33792
    buffer_load_dwordx4 v[80:83], v40, s[28:31], s59 offen offset:2048 sc1
    buffer_load_dwordx4 v[84:87], v41, s[28:31], s59 offen offset:2048 sc1
    v_mfma_f32_32x32x16_bf16 v[224:239], v[184:187], v[92:95], v[224:239]
    ds_read_b64_tr_b16 v[180:181], v35 offset:32768
    v_mfma_f32_32x32x16_bf16 v[240:255], v[188:191], v[92:95], v[240:255]
    ds_read_b64_tr_b16 v[182:183], v35 offset:33792
    s_add_u32 m0, s12, 24576
    s_nop 0
    buffer_load_dwordx4 v32, s[20:23], s16 offen lds
    buffer_load_dwordx4 v33, s[20:23], s16 offen offset:1024 lds
    s_add_u32 s16, s16, 14336
    s_waitcnt vmcnt(10) lgkmcnt(0)
    v_mfma_f32_32x32x16_bf16 v[192:207], v[176:179], v[64:67], v[192:207]
    ds_read_b64_tr_b16 v[184:185], v34 offset:40960
    v_mfma_f32_32x32x16_bf16 v[208:223], v[180:183], v[64:67], v[208:223]
    ds_read_b64_tr_b16 v[186:187], v34 offset:41984
    buffer_load_dwordx4 v[88:91], v40, s[28:31], s59 offen offset:3072 sc1
    buffer_load_dwordx4 v[92:95], v41, s[28:31], s59 offen offset:3072 sc1
    s_add_u32 s59, s59, 4096
    v_mfma_f32_32x32x16_bf16 v[224:239], v[176:179], v[68:71], v[224:239]
    ds_read_b64_tr_b16 v[188:189], v35 offset:40960
    v_mfma_f32_32x32x16_bf16 v[240:255], v[180:183], v[68:71], v[240:255]
    ds_read_b64_tr_b16 v[190:191], v35 offset:41984
    s_add_u32 m0, s12, 32768
    s_nop 0
    buffer_load_dwordx4 v32, s[20:23], s16 offen lds
    buffer_load_dwordx4 v33, s[20:23], s16 offen offset:1024 lds
    s_add_u32 s16, s16, 14336
    s_waitcnt vmcnt(10) lgkmcnt(0)
    v_mfma_f32_32x32x16_bf16 v[192:207], v[184:187], v[72:75], v[192:207]
    ds_read_b64_tr_b16 v[176:177], v34 offset:49152
    v_mfma_f32_32x32x16_bf16 v[208:223], v[188:191], v[72:75], v[208:223]
    ds_read_b64_tr_b16 v[178:179], v34 offset:50176
    buffer_load_dwordx4 v[64:67], v40, s[28:31], s59 offen offset:0 sc1
    buffer_load_dwordx4 v[68:71], v41, s[28:31], s59 offen offset:0 sc1
    v_mfma_f32_32x32x16_bf16 v[224:239], v[184:187], v[76:79], v[224:239]
    ds_read_b64_tr_b16 v[180:181], v35 offset:49152
    v_mfma_f32_32x32x16_bf16 v[240:255], v[188:191], v[76:79], v[240:255]
    ds_read_b64_tr_b16 v[182:183], v35 offset:50176
    s_add_u32 m0, s12, 40960
    s_nop 0
    buffer_load_dwordx4 v32, s[20:23], s16 offen lds
    buffer_load_dwordx4 v33, s[20:23], s16 offen offset:1024 lds
    s_add_u32 s16, s16, 14336
    s_waitcnt vmcnt(10) lgkmcnt(0)
    v_mfma_f32_32x32x16_bf16 v[192:207], v[176:179], v[80:83], v[192:207]
    ds_read_b64_tr_b16 v[184:185], v34 offset:57344
    v_mfma_f32_32x32x16_bf16 v[208:223], v[180:183], v[80:83], v[208:223]
    ds_read_b64_tr_b16 v[186:187], v34 offset:58368
    buffer_load_dwordx4 v[72:75], v40, s[28:31], s59 offen offset:1024 sc1
    buffer_load_dwordx4 v[76:79], v41, s[28:31], s59 offen offset:1024 sc1
    v_mfma_f32_32x32x16_bf16 v[224:239], v[176:179], v[84:87], v[224:239]
    ds_read_b64_tr_b16 v[188:189], v35 offset:57344
    v_mfma_f32_32x32x16_bf16 v[240:255], v[180:183], v[84:87], v[240:255]
    ds_read_b64_tr_b16 v[190:191], v35 offset:58368
    s_add_u32 m0, s12, 49152
    s_nop 0
    buffer_load_dwordx4 v32, s[20:23], s16 offen lds
    buffer_load_dwordx4 v33, s[20:23], s16 offen offset:1024 lds
    s_add_u32 s16, s16, 14336
    s_waitcnt vmcnt(10) lgkmcnt(0)
    v_mfma_f32_32x32x16_bf16 v[192:207], v[184:187], v[88:91], v[192:207]
    ds_read_b64_tr_b16 v[176:177], v36 offset:0
    v_mfma_f32_32x32x16_bf16 v[208:223], v[188:191], v[88:91], v[208:223]
    ds_read_b64_tr_b16 v[178:179], v36 offset:1024
    buffer_load_dwordx4 v[80:83], v40, s[28:31], s59 offen offset:2048 sc1
    buffer_load_dwordx4 v[84:87], v41, s[28:31], s59 offen offset:2048 sc1
    v_mfma_f32_32x32x16_bf16 v[224:239], v[184:187], v[92:95], v[224:239]
    ds_read_b64_tr_b16 v[180:181], v37 offset:0
    v_mfma_f32_32x32x16_bf16 v[240:255], v[188:191], v[92:95], v[240:255]
    ds_read_b64_tr_b16 v[182:183], v37 offset:1024
    s_add_u32 m0, s12, 57344
    s_nop 0
    buffer_load_dwordx4 v32, s[20:23], s16 offen lds
    buffer_load_dwordx4 v33, s[20:23], s16 offen offset:1024 lds
    s_add_u32 s16, s16, 14336
    s_waitcnt vmcnt(10) lgkmcnt(0)
    v_mfma_f32_32x32x16_bf16 v[192:207], v[176:179], v[64:67], v[192:207]
    ds_read_b64_tr_b16 v[184:185], v36 offset:8192
    v_mfma_f32_32x32x16_bf16 v[208:223], v[180:183], v[64:67], v[208:223]
    ds_read_b64_tr_b16 v[186:187], v36 offset:9216
    buffer_load_dwordx4 v[88:91], v40, s[28:31], s59 offen offset:3072 sc1
    buffer_load_dwordx4 v[92:95], v41, s[28:31], s59 offen offset:3072 sc1
    s_add_u32 s59, s59, 4096
    v_mfma_f32_32x32x16_bf16 v[224:239], v[176:179], v[68:71], v[224:239]
    ds_read_b64_tr_b16 v[188:189], v37 offset:8192
    v_mfma_f32_32x32x16_bf16 v[240:255], v[180:183], v[68:71], v[240:255]
    ds_read_b64_tr_b16 v[190:191], v37 offset:9216
    s_add_u32 m0, s12, 65536
    s_nop 0
    buffer_load_dwordx4 v32, s[20:23], s16 offen lds
    buffer_load_dwordx4 v33, s[20:23], s16 offen offset:1024 lds
    s_add_u32 s16, s16, 14336
    s_waitcnt vmcnt(10) lgkmcnt(0)
    v_mfma_f32_32x32x16_bf16 v[192:207], v[184:187], v[72:75], v[192:207]
    ds_read_b64_tr_b16 v[176:177], v36 offset:16384
    v_mfma_f32_32x32x16_bf16 v[208:223], v[188:191], v[72:75], v[208:223]
    ds_read_b64_tr_b16 v[178:179], v36 offset:17408
    buffer_load_dwordx4 v[64:67], v40, s[28:31], s59 offen offset:0 sc1
    buffer_load_dwordx4 v[68:71], v41, s[28:31], s59 offen offset:0 sc1
    v_mfma_f32_32x32x16_bf16 v[224:239], v[184:187], v[76:79], v[224:239]
    ds_read_b64_tr_b16 v[180:181], v37 offset:16384
    v_mfma_f32_32x32x16_bf16 v[240:255], v[188:191], v[76:79], v[240:255]
    ds_read_b64_tr_b16 v[182:183], v37 offset:17408
    s_add_u32 m0, s12, 73728
    s_nop 0
    buffer_load_dwordx4 v32, s[20:23], s16 offen lds
    buffer_load_dwordx4 v33, s[20:23], s16 offen offset:1024 lds
    s_add_u32 s16, s16, 14336
    s_waitcnt vmcnt(10) lgkmcnt(0)
    v_mfma_f32_32x32x16_bf16 v[192:207], v[176:179], v[80:83], v[192:207]
    ds_read_b64_tr_b16 v[184:185], v36 offset:24576
    v_mfma_f32_32x32x16_bf16 v[208:223], v[180:183], v[80:83], v[208:223]
    ds_read_b64_tr_b16 v[186:187], v36 offset:25600
    buffer_load_dwordx4 v[72:75], v40, s[28:31], s59 offen offset:1024 sc1
    buffer_load_dwordx4 v[76:79], v41, s[28:31], s59 offen offset:1024 sc1
    v_mfma_f32_32x32x16_bf16 v[224:239], v[176:179], v[84:87], v[224:239]
    ds_read_b64_tr_b16 v[188:189], v37 offset:24576
    v_mfma_f32_32x32x16_bf16 v[240:255], v[180:183], v[84:87], v[240:255]
    ds_read_b64_tr_b16 v[190:191], v37 offset:25600
    s_add_u32 m0, s12, 81920
    s_nop 0
    buffer_load_dwordx4 v32, s[20:23], s16 offen lds
    buffer_load_dwordx4 v33, s[20:23], s16 offen offset:1024 lds
    s_add_u32 s16, s16, 14336
    s_waitcnt vmcnt(10) lgkmcnt(0)
    v_mfma_f32_32x32x16_bf16 v[192:207], v[184:187], v[88:91], v[192:207]
    ds_read_b64_tr_b16 v[176:177], v36 offset:32768
    v_mfma_f32_32x32x16_bf16 v[208:223], v[188:191], v[88:91], v[208:223]
    ds_read_b64_tr_b16 v[178:179], v36 offset:33792
    s_mul_i32 s59, s14, 14336
    buffer_load_dwordx4 v[80:83], v40, s[28:31], s59 offen offset:0 sc1
    buffer_load_dwordx4 v[84:87], v41, s[28:31], s59 offen offset:0 sc1
    v_mfma_f32_32x32x16_bf16 v[224:239], v[184:187], v[92:95], v[224:239]
    ds_read_b64_tr_b16 v[180:181], v37 offset:32768
    v_mfma_f32_32x32x16_bf16 v[240:255], v[188:191], v[92:95], v[240:255]
    ds_read_b64_tr_b16 v[182:183], v37 offset:33792
    s_add_u32 m0, s12, 90112
    s_nop 0
    buffer_load_dwordx4 v32, s[20:23], s16 offen lds
    buffer_load_dwordx4 v33, s[20:23], s16 offen offset:1024 lds
    s_add_u32 s16, s16, 14336
    s_waitcnt vmcnt(10) lgkmcnt(0)
    v_mfma_f32_32x32x16_bf16 v[192:207], v[176:179], v[64:67], v[192:207]
    ds_read_b64_tr_b16 v[184:185], v36 offset:40960
    v_mfma_f32_32x32x16_bf16 v[208:223], v[180:183], v[64:67], v[208:223]
    ds_read_b64_tr_b16 v[186:187], v36 offset:41984
    buffer_load_dwordx4 v[88:91], v40, s[28:31], s59 offen offset:1024 sc1
    buffer_load_dwordx4 v[92:95], v41, s[28:31], s59 offen offset:1024 sc1
    v_mfma_f32_32x32x16_bf16 v[224:239], v[176:179], v[68:71], v[224:239]
    ds_read_b64_tr_b16 v[188:189], v37 offset:40960
    v_mfma_f32_32x32x16_bf16 v[240:255], v[180:183], v[68:71], v[240:255]
    ds_read_b64_tr_b16 v[190:191], v37 offset:41984
    s_add_u32 m0, s12, 98304
    s_nop 0
    buffer_load_dwordx4 v32, s[20:23], s16 offen lds
    buffer_load_dwordx4 v33, s[20:23], s16 offen offset:1024 lds
    s_add_u32 s16, s16, 14336
    s_waitcnt vmcnt(10) lgkmcnt(0)
    v_mfma_f32_32x32x16_bf16 v[192:207], v[184:187], v[72:75], v[192:207]
    ds_read_b64_tr_b16 v[176:177], v34 offset:0
    v_mfma_f32_32x32x16_bf16 v[208:223], v[188:191], v[72:75], v[208:223]
    ds_read_b64_tr_b16 v[178:179], v34 offset:1024
    buffer_load_dwordx4 v[64:67], v40, s[28:31], s59 offen offset:2048 sc1
    buffer_load_dwordx4 v[68:71], v41, s[28:31], s59 offen offset:2048 sc1
    v_mfma_f32_32x32x16_bf16 v[224:239], v[184:187], v[76:79], v[224:239]
    ds_read_b64_tr_b16 v[180:181], v35 offset:0
    v_mfma_f32_32x32x16_bf16 v[240:255], v[188:191], v[76:79], v[240:255]
    ds_read_b64_tr_b16 v[182:183], v35 offset:1024
    s_add_u32 m0, s12, 106496
    s_nop 0
    buffer_load_dwordx4 v32, s[20:23], s16 offen lds
    buffer_load_dwordx4 v33, s[20:23], s16 offen offset:1024 lds
    s_add_u32 s16, s16, 14336
    s_waitcnt vmcnt(10) lgkmcnt(0)
    v_mfma_f32_32x32x16_bf16 v[192:207], v[176:179], v[80:83], v[192:207]
    ds_read_b64_tr_b16 v[184:185], v34 offset:8192
    v_mfma_f32_32x32x16_bf16 v[208:223], v[180:183], v[80:83], v[208:223]
    ds_read_b64_tr_b16 v[186:187], v34 offset:9216
    buffer_load_dwordx4 v[72:75], v40, s[28:31], s59 offen offset:3072 sc1
    buffer_load_dwordx4 v[76:79], v41, s[28:31], s59 offen offset:3072 sc1
    s_add_u32 s59, s59, 4096
    v_mfma_f32_32x32x16_bf16 v[224:239], v[176:179], v[84:87], v[224:239]
    ds_read_b64_tr_b16 v[188:189], v35 offset:8192
    v_mfma_f32_32x32x16_bf16 v[240:255], v[180:183], v[84:87], v[240:255]
    ds_read_b64_tr_b16 v[190:191], v35 offset:9216
    s_mul_i32 s16, s8, 100352
    s_add_u32 s16, s16, s15
    s_add_u32 m0, s12, 0
    s_nop 0
    buffer_load_dwordx4 v32, s[24:27], s16 offen lds
    buffer_load_dwordx4 v33, s[24:27], s16 offen offset:1024 lds
    s_add_u32 s16, s16, 14336
    s_waitcnt vmcnt(10) lgkmcnt(0)
    v_mfma_f32_32x32x16_bf16 v[192:207], v[184:187], v[88:91], v[192:207]
    ds_read_b64_tr_b16 v[176:177], v34 offset:16384
    v_mfma_f32_32x32x16_bf16 v[208:223], v[188:191], v[88:91], v[208:223]
    ds_read_b64_tr_b16 v[178:179], v34 offset:17408
    buffer_load_dwordx4 v[80:83], v40, s[28:31], s59 offen offset:0 sc1
    buffer_load_dwordx4 v[84:87], v41, s[28:31], s59 offen offset:0 sc1
    v_mfma_f32_32x32x16_bf16 v[224:239], v[184:187], v[92:95], v[224:239]
    ds_read_b64_tr_b16 v[180:181], v35 offset:16384
    v_mfma_f32_32x32x16_bf16 v[240:255], v[188:191], v[92:95], v[240:255]
    ds_read_b64_tr_b16 v[182:183], v35 offset:17408
    s_add_u32 m0, s12, 8192
    s_nop 0
    buffer_load_dwordx4 v32, s[24:27], s16 offen lds
    buffer_load_dwordx4 v33, s[24:27], s16 offen offset:1024 lds
    s_add_u32 s16, s16, 10752
    s_waitcnt vmcnt(10) lgkmcnt(0)
    v_mfma_f32_32x32x16_bf16 v[192:207], v[176:179], v[64:67], v[192:207]
    ds_read_b64_tr_b16 v[184:185], v34 offset:24576
    v_mfma_f32_32x32x16_bf16 v[208:223], v[180:183], v[64:67], v[208:223]
    ds_read_b64_tr_b16 v[186:187], v34 offset:25600
    buffer_load_dwordx4 v[88:91], v40, s[28:31], s59 offen offset:1024 sc1
    buffer_load_dwordx4 v[92:95], v41, s[28:31], s59 offen offset:1024 sc1
    v_mfma_f32_32x32x16_bf16 v[224:239], v[176:179], v[68:71], v[224:239]
    ds_read_b64_tr_b16 v[188:189], v35 offset:24576
    v_mfma_f32_32x32x16_bf16 v[240:255], v[180:183], v[68:71], v[240:255]
    ds_read_b64_tr_b16 v[190:191], v35 offset:25600
    s_add_u32 m0, s12, 16384
    s_nop 0
    buffer_load_dwordx4 v32, s[24:27], s16 offen lds
    buffer_load_dwordx4 v33, s[24:27], s16 offen offset:1024 lds
    s_add_u32 s16, s16, 14336
    s_waitcnt vmcnt(10) lgkmcnt(0)
    v_mfma_f32_32x32x16_bf16 v[192:207], v[184:187], v[72:75], v[192:207]
    ds_read_b64_tr_b16 v[176:177], v34 offset:32768
    v_mfma_f32_32x32x16_bf16 v[208:223], v[188:191], v[72:75], v[208:223]
    ds_read_b64_tr_b16 v[178:179], v34 offset:33792
    buffer_load_dwordx4 v[64:67], v40, s[28:31], s59 offen offset:2048 sc1
    buffer_load_dwordx4 v[68:71], v41, s[28:31], s59 offen offset:2048 sc1
    v_mfma_f32_32x32x16_bf16 v[224:239], v[184:187], v[76:79], v[224:239]
    ds_read_b64_tr_b16 v[180:181], v35 offset:32768
    v_mfma_f32_32x32x16_bf16 v[240:255], v[188:191], v[76:79], v[240:255]
    ds_read_b64_tr_b16 v[182:183], v35 offset:33792
    s_add_u32 m0, s12, 24576
    s_nop 0
    buffer_load_dwordx4 v32, s[24:27], s16 offen lds
    buffer_load_dwordx4 v33, s[24:27], s16 offen offset:1024 lds
    s_add_u32 s16, s16, 10752
    s_waitcnt vmcnt(10) lgkmcnt(0)
    v_mfma_f32_32x32x16_bf16 v[192:207], v[176:179], v[80:83], v[192:207]
    ds_read_b64_tr_b16 v[184:185], v34 offset:40960
    v_mfma_f32_32x32x16_bf16 v[208:223], v[180:183], v[80:83], v[208:223]
    ds_read_b64_tr_b16 v[186:187], v34 offset:41984
    buffer_load_dwordx4 v[72:75], v40, s[28:31], s59 offen offset:3072 sc1
    buffer_load_dwordx4 v[76:79], v41, s[28:31], s59 offen offset:3072 sc1
    s_add_u32 s59, s59, 4096
    v_mfma_f32_32x32x16_bf16 v[224:239], v[176:179], v[84:87], v[224:239]
    ds_read_b64_tr_b16 v[188:189], v35 offset:40960
    v_mfma_f32_32x32x16_bf16 v[240:255], v[180:183], v[84:87], v[240:255]
    ds_read_b64_tr_b16 v[190:191], v35 offset:41984
    s_add_u32 m0, s12, 32768
    s_nop 0
    buffer_load_dwordx4 v32, s[24:27], s16 offen lds
    buffer_load_dwordx4 v33, s[24:27], s16 offen offset:1024 lds
    s_add_u32 s16, s16, 14336
    s_waitcnt vmcnt(10) lgkmcnt(0)
    v_mfma_f32_32x32x16_bf16 v[192:207], v[184:187], v[88:91], v[192:207]
    ds_read_b64_tr_b16 v[176:177], v34 offset:49152
    v_mfma_f32_32x32x16_bf16 v[208:223], v[188:191], v[88:91], v[208:223]
    ds_read_b64_tr_b16 v[178:179], v34 offset:50176
    buffer_load_dwordx4 v[80:83], v40, s[28:31], s59 offen offset:0 sc1
    buffer_load_dwordx4 v[84:87], v41, s[28:31], s59 offen offset:0 sc1
    v_mfma_f32_32x32x16_bf16 v[224:239], v[184:187], v[92:95], v[224:239]
    ds_read_b64_tr_b16 v[180:181], v35 offset:49152
    v_mfma_f32_32x32x16_bf16 v[240:255], v[188:191], v[92:95], v[240:255]
    ds_read_b64_tr_b16 v[182:183], v35 offset:50176
    s_add_u32 m0, s12, 40960
    s_nop 0
    buffer_load_dwordx4 v32, s[24:27], s16 offen lds
    buffer_load_dwordx4 v33, s[24:27], s16 offen offset:1024 lds
    s_add_u32 s16, s16, 10752
    s_waitcnt vmcnt(10) lgkmcnt(0)
    v_mfma_f32_32x32x16_bf16 v[192:207], v[176:179], v[64:67], v[192:207]
    ds_read_b64_tr_b16 v[184:185], v34 offset:57344
    v_mfma_f32_32x32x16_bf16 v[208:223], v[180:183], v[64:67], v[208:223]
    ds_read_b64_tr_b16 v[186:187], v34 offset:58368
    buffer_load_dwordx4 v[88:91], v40, s[28:31], s59 offen offset:1024 sc1
    buffer_load_dwordx4 v[92:95], v41, s[28:31], s59 offen offset:1024 sc1
    v_mfma_f32_32x32x16_bf16 v[224:239], v[176:179], v[68:71], v[224:239]
    ds_read_b64_tr_b16 v[188:189], v35 offset:57344
    v_mfma_f32_32x32x16_bf16 v[240:255], v[180:183], v[68:71], v[240:255]
    ds_read_b64_tr_b16 v[190:191], v35 offset:58368
    s_add_u32 m0, s12, 49152
    s_nop 0
    buffer_load_dwordx4 v32, s[24:27], s16 offen lds
    buffer_load_dwordx4 v33, s[24:27], s16 offen offset:1024 lds
    s_add_u32 s16, s16, 14336
    s_waitcnt vmcnt(10) lgkmcnt(0)
    v_mfma_f32_32x32x16_bf16 v[192:207], v[184:187], v[72:75], v[192:207]
    ds_read_b64_tr_b16 v[176:177], v36 offset:0
    v_mfma_f32_32x32x16_bf16 v[208:223], v[188:191], v[72:75], v[208:223]
    ds_read_b64_tr_b16 v[178:179], v36 offset:1024
    buffer_load_dwordx4 v[64:67], v40, s[28:31], s59 offen offset:2048 sc1
    buffer_load_dwordx4 v[68:71], v41, s[28:31], s59 offen offset:2048 sc1
    v_mfma_f32_32x32x16_bf16 v[224:239], v[184:187], v[76:79], v[224:239]
    ds_read_b64_tr_b16 v[180:181], v37 offset:0
    v_mfma_f32_32x32x16_bf16 v[240:255], v[188:191], v[76:79], v[240:255]
    ds_read_b64_tr_b16 v[182:183], v37 offset:1024
    s_add_u32 m0, s12, 57344
    s_nop 0
    buffer_load_dwordx4 v32, s[24:27], s16 offen lds
    buffer_load_dwordx4 v33, s[24:27], s16 offen offset:1024 lds
    s_add_u32 s16, s16, 10752
    s_waitcnt vmcnt(10) lgkmcnt(0)
    v_mfma_f32_32x32x16_bf16 v[192:207], v[176:179], v[80:83], v[192:207]
    ds_read_b64_tr_b16 v[184:185], v36 offset:8192
    v_mfma_f32_32x32x16_bf16 v[208:223], v[180:183], v[80:83], v[208:223]
    ds_read_b64_tr_b16 v[186:187], v36 offset:9216
    buffer_load_dwordx4 v[72:75], v40, s[28:31], s59 offen offset:3072 sc1
    buffer_load_dwordx4 v[76:79], v41, s[28:31], s59 offen offset:3072 sc1
    s_add_u32 s59, s59, 4096
    v_mfma_f32_32x32x16_bf16 v[224:239], v[176:179], v[84:87], v[224:239]
    ds_read_b64_tr_b16 v[188:189], v37 offset:8192
    v_mfma_f32_32x32x16_bf16 v[240:255], v[180:183], v[84:87], v[240:255]
    ds_read_b64_tr_b16 v[190:191], v37 offset:9216
    s_waitcnt vmcnt(8) lgkmcnt(0)
    v_mfma_f32_32x32x16_bf16 v[192:207], v[184:187], v[88:91], v[192:207]
    ds_read_b64_tr_b16 v[176:177], v36 offset:16384
    v_mfma_f32_32x32x16_bf16 v[208:223], v[188:191], v[88:91], v[208:223]
    ds_read_b64_tr_b16 v[178:179], v36 offset:17408
    buffer_load_dwordx4 v[80:83], v40, s[28:31], s59 offen offset:0 sc1
    buffer_load_dwordx4 v[84:87], v41, s[28:31], s59 offen offset:0 sc1
    v_mfma_f32_32x32x16_bf16 v[224:239], v[184:187], v[92:95], v[224:239]
    ds_read_b64_tr_b16 v[180:181], v37 offset:16384
    v_mfma_f32_32x32x16_bf16 v[240:255], v[188:191], v[92:95], v[240:255]
    ds_read_b64_tr_b16 v[182:183], v37 offset:17408
    s_waitcnt vmcnt(6) lgkmcnt(0)
    v_mfma_f32_32x32x16_bf16 v[192:207], v[176:179], v[64:67], v[192:207]
    ds_read_b64_tr_b16 v[184:185], v36 offset:24576
    v_mfma_f32_32x32x16_bf16 v[208:223], v[180:183], v[64:67], v[208:223]
    ds_read_b64_tr_b16 v[186:187], v36 offset:25600
    buffer_load_dwordx4 v[88:91], v40, s[28:31], s59 offen offset:1024 sc1
    buffer_load_dwordx4 v[92:95], v41, s[28:31], s59 offen offset:1024 sc1
    v_mfma_f32_32x32x16_bf16 v[224:239], v[176:179], v[68:71], v[224:239]
    ds_read_b64_tr_b16 v[188:189], v37 offset:24576
    v_mfma_f32_32x32x16_bf16 v[240:255], v[180:183], v[68:71], v[240:255]
    ds_read_b64_tr_b16 v[190:191], v37 offset:25600
    s_waitcnt vmcnt(4) lgkmcnt(0)
    s_mov_b64 exec, 1
    ds_add_u32 v25, v26 offset:40
    s_mov_b64 exec, -1
    v_mfma_f32_32x32x16_bf16 v[192:207], v[184:187], v[72:75], v[192:207]
    ds_read_b64_tr_b16 v[176:177], v36 offset:32768
    v_mfma_f32_32x32x16_bf16 v[208:223], v[188:191], v[72:75], v[208:223]
    ds_read_b64_tr_b16 v[178:179], v36 offset:33792
    v_mfma_f32_32x32x16_bf16 v[224:239], v[184:187], v[76:79], v[224:239]
    ds_read_b64_tr_b16 v[180:181], v37 offset:32768
    v_mfma_f32_32x32x16_bf16 v[240:255], v[188:191], v[76:79], v[240:255]
    ds_read_b64_tr_b16 v[182:183], v37 offset:33792
    s_waitcnt vmcnt(2) lgkmcnt(0)
    v_mfma_f32_32x32x16_bf16 v[192:207], v[176:179], v[80:83], v[192:207]
    ds_read_b64_tr_b16 v[184:185], v36 offset:40960
    v_mfma_f32_32x32x16_bf16 v[208:223], v[180:183], v[80:83], v[208:223]
    ds_read_b64_tr_b16 v[186:187], v36 offset:41984
    v_mfma_f32_32x32x16_bf16 v[224:239], v[176:179], v[84:87], v[224:239]
    ds_read_b64_tr_b16 v[188:189], v37 offset:40960
    v_mfma_f32_32x32x16_bf16 v[240:255], v[180:183], v[84:87], v[240:255]
    ds_read_b64_tr_b16 v[190:191], v37 offset:41984
    s_waitcnt vmcnt(0) lgkmcnt(0)
    v_mfma_f32_32x32x16_bf16 v[192:207], v[184:187], v[88:91], v[192:207]
    ds_read_b64 v[22:23], v25 offset:32
    v_mfma_f32_32x32x16_bf16 v[208:223], v[188:191], v[88:91], v[208:223]
    ds_read_b32 v24, v25 offset:40
    v_mfma_f32_32x32x16_bf16 v[224:239], v[184:187], v[92:95], v[224:239]
    v_mfma_f32_32x32x16_bf16 v[240:255], v[188:191], v[92:95], v[240:255]
    s_setprio 2
    s_mov_b32 s52, 0
    s_mov_b32 s53, 4096
    s_mov_b32 s54, 8192
    s_mov_b32 s55, 12288
    s_waitcnt lgkmcnt(0)
    v_readfirstlane_b32 s67, v23
    v_readfirstlane_b32 s63, v24
    v_sub_f32 v9, 1.0, v9
    s_cmp_lt_u32 s67, 4
    s_cbranch_scc1 L_ge_ne
    buffer_load_dwordx4 v[96:99], v45, s[28:31], s52 offen offset:0 sc1
    buffer_load_dwordx4 v[100:103], v45, s[28:31], s52 offen offset:1024 sc1
    buffer_load_dwordx4 v[104:107], v45, s[28:31], s52 offen offset:2048 sc1
    buffer_load_dwordx4 v[108:111], v45, s[28:31], s52 offen offset:3072 sc1
    buffer_load_dwordx4 v[112:115], v45, s[28:31], s53 offen offset:0 sc1
    buffer_load_dwordx4 v[116:119], v45, s[28:31], s53 offen offset:1024 sc1
    buffer_load_dwordx4 v[120:123], v45, s[28:31], s53 offen offset:2048 sc1
    buffer_load_dwordx4 v[124:127], v45, s[28:31], s53 offen offset:3072 sc1
    buffer_load_dwordx4 v[128:131], v45, s[28:31], s54 offen offset:0 sc1
    buffer_load_dwordx4 v[132:135], v45, s[28:31], s54 offen offset:1024 sc1
    buffer_load_dwordx4 v[136:139], v45, s[28:31], s54 offen offset:2048 sc1
    buffer_load_dwordx4 v[140:143], v45, s[28:31], s54 offen offset:3072 sc1
    buffer_load_dwordx4 v[144:147], v45, s[28:31], s55 offen offset:0 sc1
    buffer_load_dwordx4 v[148:151], v45, s[28:31], s55 offen offset:1024 sc1
    buffer_load_dwordx4 v[152:155], v45, s[28:31], s55 offen offset:2048 sc1
    buffer_load_dwordx4 v[156:159], v45, s[28:31], s55 offen offset:3072 sc1
L_ge_ne:
    s_cmp_ge_u32 s63, 4
    s_cbranch_scc1 L_ge_wl_x
    s_mov_b32 s62, 1048576
L_ge_wl:
    ds_read_b32 v24, v25 offset:40
    s_waitcnt lgkmcnt(0)
    v_readfirstlane_b32 s63, v24
    s_sub_u32 s62, s62, 1
    s_cmp_eq_u32 s62, 0
    s_cbranch_scc1 L_ge_wl_x
    s_cmp_lt_u32 s63, 4
    s_cbranch_scc1 L_ge_wl
L_ge_wl_x:
    ds_write_b128 v47, v[224:227] offset:0
    ds_write_b128 v47, v[228:231] offset:1024
    ds_write_b128 v47, v[232:235] offset:8192
    ds_write_b128 v47, v[236:239] offset:9216
    ds_write_b128 v47, v[240:243] offset:16384
    ds_write_b128 v47, v[244:247] offset:17408
    ds_write_b128 v47, v[248:251] offset:24576
    ds_write_b128 v47, v[252:255] offset:25600
    s_mov_b64 exec, 1
    ds_add_u32 v25, v26 offset:24
    s_mov_b64 exec, -1
    ds_read_b64_tr_b16 v[68:69], v39 offset:0
    ds_read_b64_tr_b16 v[70:71], v39 offset:1024
    ds_read_b64_tr_b16 v[64:65], v38 offset:0
    ds_read_b64_tr_b16 v[66:67], v38 offset:1024
    ds_read_b64_tr_b16 v[76:77], v39 offset:8192
    ds_read_b64_tr_b16 v[78:79], v39 offset:9216
    ds_read_b64_tr_b16 v[72:73], v38 offset:8192
    ds_read_b64_tr_b16 v[74:75], v38 offset:9216
    ds_read_b64_tr_b16 v[84:85], v39 offset:16384
    ds_read_b64_tr_b16 v[86:87], v39 offset:17408
    ds_read_b64_tr_b16 v[80:81], v38 offset:16384
    ds_read_b64_tr_b16 v[82:83], v38 offset:17408
    ds_read_b64_tr_b16 v[92:93], v39 offset:24576
    ds_read_b64_tr_b16 v[94:95], v39 offset:25600
    ds_read_b64_tr_b16 v[88:89], v38 offset:24576
    ds_read_b64_tr_b16 v[90:91], v38 offset:25600
    ds_read_b64_tr_b16 v[164:165], v39 offset:32768
    ds_read_b64_tr_b16 v[166:167], v39 offset:33792
    ds_read_b64_tr_b16 v[160:161], v38 offset:32768
    ds_read_b64_tr_b16 v[162:163], v38 offset:33792
    ds_read_b64_tr_b16 v[172:173], v39 offset:40960
    ds_read_b64_tr_b16 v[174:175], v39 offset:41984
    ds_read_b64_tr_b16 v[168:169], v38 offset:40960
    ds_read_b64_tr_b16 v[170:171], v38 offset:41984
    ds_read_b64_tr_b16 v[180:181], v39 offset:49152
    ds_read_b64_tr_b16 v[182:183], v39 offset:50176
    ds_read_b64_tr_b16 v[176:177], v38 offset:49152
    ds_read_b64_tr_b16 v[178:179], v38 offset:50176
    ds_read_b64_tr_b16 v[188:189], v39 offset:57344
    ds_read_b64_tr_b16 v[190:191], v39 offset:58368
    ds_read_b64_tr_b16 v[184:185], v38 offset:57344
    ds_read_b64_tr_b16 v[186:187], v38 offset:58368
    v_mul_f32 v192, v9, v192
    v_mul_f32 v193, v9, v193
    v_mul_f32 v194, v9, v194
    v_mul_f32 v195, v9, v195
    v_mul_f32 v196, v9, v196
    v_mul_f32 v197, v9, v197
    v_mul_f32 v198, v9, v198
    v_mul_f32 v199, v9, v199
    v_mul_f32 v200, v9, v200
    v_mul_f32 v201, v9, v201
    v_mul_f32 v202, v9, v202
    v_mul_f32 v203, v9, v203
    v_mul_f32 v204, v9, v204
    v_mul_f32 v205, v9, v205
    v_mul_f32 v206, v9, v206
    v_mul_f32 v207, v9, v207
    v_mul_f32 v208, v9, v208
    v_mul_f32 v209, v9, v209
    v_mul_f32 v210, v9, v210
    v_mul_f32 v211, v9, v211
    v_mul_f32 v212, v9, v212
    v_mul_f32 v213, v9, v213
    v_mul_f32 v214, v9, v214
    v_mul_f32 v215, v9, v215
    v_mul_f32 v216, v9, v216
    v_mul_f32 v217, v9, v217
    v_mul_f32 v218, v9, v218
    v_mul_f32 v219, v9, v219
    v_mul_f32 v220, v9, v220
    v_mul_f32 v221, v9, v221
    v_mul_f32 v222, v9, v222
    v_mul_f32 v223, v9, v223
    v_xor_b32 v46, 4096, v48
    s_mul_i32 s66, s11, 28672
    s_add_u32 s66, s66, s15
    s_lshl_b32 s71, s10, 6
    s_add_u32 s66, s66, s71
    s_cmp_ge_u32 s67, 4
    s_cbranch_scc1 L_ge_ld
    s_mov_b32 s62, 1048576
L_ge_ad:
    ds_read_b32 v24, v25 offset:36
    s_waitcnt lgkmcnt(0)
    v_readfirstlane_b32 s63, v24
    s_sub_u32 s62, s62, 1
    s_cmp_eq_u32 s62, 0
    s_cbranch_scc1 L_ge_ad_x
    s_cmp_ge_u32 s63, 4
    s_cbranch_scc1 L_ge_ad_x
    s_sleep 1
    s_branch L_ge_ad
L_ge_ad_x:
    buffer_load_dwordx4 v[96:99], v45, s[28:31], s52 offen offset:0 sc1
    buffer_load_dwordx4 v[100:103], v45, s[28:31], s52 offen offset:1024 sc1
    buffer_load_dwordx4 v[104:107], v45, s[28:31], s52 offen offset:2048 sc1
    buffer_load_dwordx4 v[108:111], v45, s[28:31], s52 offen offset:3072 sc1
    buffer_load_dwordx4 v[112:115], v45, s[28:31], s53 offen offset:0 sc1
    buffer_load_dwordx4 v[116:119], v45, s[28:31], s53 offen offset:1024 sc1
    buffer_load_dwordx4 v[120:123], v45, s[28:31], s53 offen offset:2048 sc1
    buffer_load_dwordx4 v[124:127], v45, s[28:31], s53 offen offset:3072 sc1
    buffer_load_dwordx4 v[128:131], v45, s[28:31], s54 offen offset:0 sc1
    buffer_load_dwordx4 v[132:135], v45, s[28:31], s54 offen offset:1024 sc1
    buffer_load_dwordx4 v[136:139], v45, s[28:31], s54 offen offset:2048 sc1
    buffer_load_dwordx4 v[140:143], v45, s[28:31], s54 offen offset:3072 sc1
    buffer_load_dwordx4 v[144:147], v45, s[28:31], s55 offen offset:0 sc1
    buffer_load_dwordx4 v[148:151], v45, s[28:31], s55 offen offset:1024 sc1
    buffer_load_dwordx4 v[152:155], v45, s[28:31], s55 offen offset:2048 sc1
    buffer_load_dwordx4 v[156:159], v45, s[28:31], s55 offen offset:3072 sc1
L_ge_ld:
    s_mov_b32 s62, 1048576
L_gx:
    ds_read_b32 v24, v25 offset:24
    s_waitcnt lgkmcnt(0)
    v_readfirstlane_b32 s63, v24
    s_sub_u32 s62, s62, 1
    s_cmp_eq_u32 s62, 0
    s_cbranch_scc1 L_gx_x
    s_cmp_lt_u32 s63, 4
    s_cbranch_scc1 L_gx
L_gx_x:
    ds_read_b128 v[224:227], v48 offset:0
    ds_read_b128 v[228:231], v48 offset:1024
    ds_read_b128 v[232:235], v48 offset:8192
    ds_read_b128 v[236:239], v48 offset:9216
    ds_read_b128 v[240:243], v46 offset:16384
    ds_read_b128 v[244:247], v46 offset:17408
    ds_read_b128 v[248:251], v46 offset:24576
    ds_read_b128 v[252:255], v46 offset:25600
    s_waitcnt lgkmcnt(0)
    v_add_f32 v224, v224, v240
    v_add_f32 v225, v225, v241
    v_add_f32 v226, v226, v242
    v_add_f32 v227, v227, v243
    v_add_f32 v228, v228, v244
    v_add_f32 v229, v229, v245
    v_add_f32 v230, v230, v246
    v_add_f32 v231, v231, v247
    v_add_f32 v232, v232, v248
    v_add_f32 v233, v233, v249
    v_add_f32 v234, v234, v250
    v_add_f32 v235, v235, v251
    v_add_f32 v236, v236, v252
    v_add_f32 v237, v237, v253
    v_add_f32 v238, v238, v254
    v_add_f32 v239, v239, v255
    v_fmac_f32 v192, v9, v224
    v_fmac_f32 v193, v9, v225
    v_fmac_f32 v194, v9, v226
    v_fmac_f32 v195, v9, v227
    v_fmac_f32 v196, v9, v228
    v_fmac_f32 v197, v9, v229
    v_fmac_f32 v198, v9, v230
    v_fmac_f32 v199, v9, v231
    v_fmac_f32 v200, v9, v232
    v_fmac_f32 v201, v9, v233
    v_fmac_f32 v202, v9, v234
    v_fmac_f32 v203, v9, v235
    v_fmac_f32 v204, v9, v236
    v_fmac_f32 v205, v9, v237
    v_fmac_f32 v206, v9, v238
    v_fmac_f32 v207, v9, v239
    s_mov_b32 s62, 131072
L_ge_c0:
    s_waitcnt vmcnt(12)
    v_max3_u32 v17, v96, v97, v98
    v_max3_u32 v18, v99, v100, v101
    v_max3_u32 v17, v17, v102, v103
    v_max3_u32 v18, v18, v104, v105
    v_max3_u32 v17, v17, v106, v107
    v_max3_u32 v18, v18, v108, v109
    v_max3_u32 v17, v17, v110, v111
    v_max_u32 v17, v17, v18
    v_cmp_eq_u32 vcc, -1, v17
    s_cbranch_vccnz L_ge_r0
L_ge_k0:
    v_mfma_f32_32x32x16_bf16 v[208:223], v[68:71], v[96:99], v[208:223]
    ds_read_b64_tr_b16 v[68:69], v39 offset:2048
    ds_read_b64_tr_b16 v[70:71], v39 offset:3072
    v_mfma_f32_32x32x16_bf16 v[208:223], v[76:79], v[100:103], v[208:223]
    ds_read_b64_tr_b16 v[76:77], v39 offset:10240
    ds_read_b64_tr_b16 v[78:79], v39 offset:11264
    v_mfma_f32_32x32x16_bf16 v[208:223], v[84:87], v[104:107], v[208:223]
    ds_read_b64_tr_b16 v[84:85], v39 offset:18432
    ds_read_b64_tr_b16 v[86:87], v39 offset:19456
    v_mfma_f32_32x32x16_bf16 v[208:223], v[92:95], v[108:111], v[208:223]
    ds_read_b64_tr_b16 v[92:93], v39 offset:26624
    ds_read_b64_tr_b16 v[94:95], v39 offset:27648
    v_mfma_f32_32x32x16_bf16 v[192:207], v[64:67], v[96:99], v[192:207]
    ds_read_b64_tr_b16 v[64:65], v38 offset:2048
    ds_read_b64_tr_b16 v[66:67], v38 offset:3072
    v_mfma_f32_32x32x16_bf16 v[192:207], v[72:75], v[100:103], v[192:207]
    ds_read_b64_tr_b16 v[72:73], v38 offset:10240
    ds_read_b64_tr_b16 v[74:75], v38 offset:11264
    v_mfma_f32_32x32x16_bf16 v[192:207], v[80:83], v[104:107], v[192:207]
    ds_read_b64_tr_b16 v[80:81], v38 offset:18432
    ds_read_b64_tr_b16 v[82:83], v38 offset:19456
    v_mfma_f32_32x32x16_bf16 v[192:207], v[88:91], v[108:111], v[192:207]
    ds_read_b64_tr_b16 v[88:89], v38 offset:26624
    ds_read_b64_tr_b16 v[90:91], v38 offset:27648
L_ge_c1:
    s_waitcnt vmcnt(8)
    v_max3_u32 v17, v112, v113, v114
    v_max3_u32 v18, v115, v116, v117
    v_max3_u32 v17, v17, v118, v119
    v_max3_u32 v18, v18, v120, v121
    v_max3_u32 v17, v17, v122, v123
    v_max3_u32 v18, v18, v124, v125
    v_max3_u32 v17, v17, v126, v127
    v_max_u32 v17, v17, v18
    v_cmp_eq_u32 vcc, -1, v17
    s_cbranch_vccnz L_ge_r1
L_ge_k1:
    v_mfma_f32_32x32x16_bf16 v[208:223], v[164:167], v[112:115], v[208:223]
    ds_read_b64_tr_b16 v[164:165], v39 offset:34816
    ds_read_b64_tr_b16 v[166:167], v39 offset:35840
    v_mfma_f32_32x32x16_bf16 v[208:223], v[172:175], v[116:119], v[208:223]
    ds_read_b64_tr_b16 v[172:173], v39 offset:43008
    ds_read_b64_tr_b16 v[174:175], v39 offset:44032
    v_mfma_f32_32x32x16_bf16 v[208:223], v[180:183], v[120:123], v[208:223]
    ds_read_b64_tr_b16 v[180:181], v39 offset:51200
    ds_read_b64_tr_b16 v[182:183], v39 offset:52224
    v_mfma_f32_32x32x16_bf16 v[208:223], v[188:191], v[124:127], v[208:223]
    ds_read_b64_tr_b16 v[188:189], v39 offset:59392
    ds_read_b64_tr_b16 v[190:191], v39 offset:60416
    v_mfma_f32_32x32x16_bf16 v[192:207], v[160:163], v[112:115], v[192:207]
    ds_read_b64_tr_b16 v[160:161], v38 offset:34816
    ds_read_b64_tr_b16 v[162:163], v38 offset:35840
    v_mfma_f32_32x32x16_bf16 v[192:207], v[168:171], v[116:119], v[192:207]
    ds_read_b64_tr_b16 v[168:169], v38 offset:43008
    ds_read_b64_tr_b16 v[170:171], v38 offset:44032
    v_mfma_f32_32x32x16_bf16 v[192:207], v[176:179], v[120:123], v[192:207]
    ds_read_b64_tr_b16 v[176:177], v38 offset:51200
    ds_read_b64_tr_b16 v[178:179], v38 offset:52224
    v_mfma_f32_32x32x16_bf16 v[192:207], v[184:187], v[124:127], v[192:207]
    ds_read_b64_tr_b16 v[184:185], v38 offset:59392
    ds_read_b64_tr_b16 v[186:187], v38 offset:60416
L_ge_c2:
    s_waitcnt vmcnt(4)
    v_max3_u32 v17, v128, v129, v130
    v_max3_u32 v18, v131, v132, v133
    v_max3_u32 v17, v17, v134, v135
    v_max3_u32 v18, v18, v136, v137
    v_max3_u32 v17, v17, v138, v139
    v_max3_u32 v18, v18, v140, v141
    v_max3_u32 v17, v17, v142, v143
    v_max_u32 v17, v17, v18
    v_cmp_eq_u32 vcc, -1, v17
    s_cbranch_vccnz L_ge_r2
L_ge_k2:
    s_waitcnt lgkmcnt(15)
    v_mfma_f32_32x32x16_bf16 v[208:223], v[68:71], v[128:131], v[208:223]
    v_mfma_f32_32x32x16_bf16 v[208:223], v[76:79], v[132:135], v[208:223]
    v_mfma_f32_32x32x16_bf16 v[208:223], v[84:87], v[136:139], v[208:223]
    v_mfma_f32_32x32x16_bf16 v[208:223], v[92:95], v[140:143], v[208:223]
L_ge_c3:
    s_waitcnt vmcnt(0)
    v_max3_u32 v17, v144, v145, v146
    v_max3_u32 v18, v147, v148, v149
    v_max3_u32 v17, v17, v150, v151
    v_max3_u32 v18, v18, v152, v153
    v_max3_u32 v17, v17, v154, v155
    v_max3_u32 v18, v18, v156, v157
    v_max3_u32 v17, v17, v158, v159
    v_max_u32 v17, v17, v18
    v_cmp_eq_u32 vcc, -1, v17
    s_cbranch_vccnz L_ge_r3
L_ge_k3:
    s_waitcnt lgkmcnt(0)
    v_mfma_f32_32x32x16_bf16 v[208:223], v[164:167], v[144:147], v[208:223]
    v_mfma_f32_32x32x16_bf16 v[208:223], v[172:175], v[148:151], v[208:223]
    v_mfma_f32_32x32x16_bf16 v[208:223], v[180:183], v[152:155], v[208:223]
    v_mfma_f32_32x32x16_bf16 v[208:223], v[188:191], v[156:159], v[208:223]
    v_mfma_f32_32x32x16_bf16 v[192:207], v[64:67], v[128:131], v[192:207]
    s_nop 5
    v_mfma_f32_32x32x16_bf16 v[192:207], v[72:75], v[132:135], v[192:207]
    s_nop 3
    ds_write_b128 v47, v[208:211] offset:32768
    ds_write_b128 v47, v[212:215] offset:33792
    ds_write_b128 v47, v[216:219] offset:40960
    ds_write_b128 v47, v[220:223] offset:41984
    v_mfma_f32_32x32x16_bf16 v[192:207], v[80:83], v[136:139], v[192:207]
    v_mfma_f32_32x32x16_bf16 v[192:207], v[88:91], v[140:143], v[192:207]
    v_mfma_f32_32x32x16_bf16 v[192:207], v[160:163], v[144:147], v[192:207]
    s_waitcnt lgkmcnt(0)
    s_barrier
    ds_read_b128 v[208:211], v49 offset:32768
    ds_read_b128 v[212:215], v49 offset:33792
    ds_read_b128 v[216:219], v49 offset:40960
    ds_read_b128 v[220:223], v49 offset:41984
    v_mfma_f32_32x32x16_bf16 v[192:207], v[168:171], v[148:151], v[192:207]
    v_mfma_f32_32x32x16_bf16 v[192:207], v[176:179], v[152:155], v[192:207]
    v_mfma_f32_32x32x16_bf16 v[192:207], v[184:187], v[156:159], v[192:207]
    s_nop 10
    s_waitcnt lgkmcnt(2)
    v_add_f32 v192, v192, v208
    v_add_f32 v193, v193, v209
    v_add_f32 v194, v194, v210
    v_add_f32 v195, v195, v211
    v_add_f32 v196, v196, v212
    v_add_f32 v197, v197, v213
    v_add_f32 v198, v198, v214
    v_add_f32 v199, v199, v215
    v_cvt_pk_bf16_f32 v56, v192, v193
    v_cvt_pk_bf16_f32 v57, v194, v195
    v_cvt_pk_bf16_f32 v58, v196, v197
    v_cvt_pk_bf16_f32 v59, v198, v199
    s_nop 0
    v_permlane32_swap_b32 v56, v58
    v_permlane32_swap_b32 v57, v59
    buffer_store_dwordx4 v[56:59], v50, s[32:35], s66 offen offset:0
    s_waitcnt lgkmcnt(0)
    v_add_f32 v200, v200, v216
    v_add_f32 v201, v201, v217
    v_add_f32 v202, v202, v218
    v_add_f32 v203, v203, v219
    v_add_f32 v204, v204, v220
    v_add_f32 v205, v205, v221
    v_add_f32 v206, v206, v222
    v_add_f32 v207, v207, v223
    v_cvt_pk_bf16_f32 v60, v200, v201
    v_cvt_pk_bf16_f32 v61, v202, v203
    v_cvt_pk_bf16_f32 v62, v204, v205
    v_cvt_pk_bf16_f32 v63, v206, v207
    s_nop 0
    v_permlane32_swap_b32 v60, v62
    v_permlane32_swap_b32 v61, v63
    buffer_store_dwordx4 v[60:63], v50, s[32:35], s66 offen offset:32
    s_endpgm
L_ge_r0:
    s_cmp_eq_u32 s62, 0
    s_cbranch_scc1 L_ge_k0
    s_sub_u32 s62, s62, 1
    s_mov_b32 s67, 0
    s_waitcnt vmcnt(0)
    buffer_load_dwordx4 v[96:99], v45, s[28:31], s52 offen offset:0 sc1
    buffer_load_dwordx4 v[100:103], v45, s[28:31], s52 offen offset:1024 sc1
    buffer_load_dwordx4 v[104:107], v45, s[28:31], s52 offen offset:2048 sc1
    buffer_load_dwordx4 v[108:111], v45, s[28:31], s52 offen offset:3072 sc1
    s_branch L_ge_l1
L_ge_r1:
    s_cmp_eq_u32 s62, 0
    s_cbranch_scc1 L_ge_k1
    s_sub_u32 s62, s62, 1
    s_mov_b32 s67, 1
    s_waitcnt vmcnt(0)
    buffer_load_dwordx4 v[112:115], v45, s[28:31], s53 offen offset:0 sc1
    buffer_load_dwordx4 v[116:119], v45, s[28:31], s53 offen offset:1024 sc1
    buffer_load_dwordx4 v[120:123], v45, s[28:31], s53 offen offset:2048 sc1
    buffer_load_dwordx4 v[124:127], v45, s[28:31], s53 offen offset:3072 sc1
    s_branch L_ge_l2
L_ge_r2:
    s_cmp_eq_u32 s62, 0
    s_cbranch_scc1 L_ge_k2
    s_sub_u32 s62, s62, 1
    s_mov_b32 s67, 2
    s_waitcnt vmcnt(0)
    buffer_load_dwordx4 v[128:131], v45, s[28:31], s54 offen offset:0 sc1
    buffer_load_dwordx4 v[132:135], v45, s[28:31], s54 offen offset:1024 sc1
    buffer_load_dwordx4 v[136:139], v45, s[28:31], s54 offen offset:2048 sc1
    buffer_load_dwordx4 v[140:143], v45, s[28:31], s54 offen offset:3072 sc1
    s_branch L_ge_l3
L_ge_r3:
    s_cmp_eq_u32 s62, 0
    s_cbranch_scc1 L_ge_k3
    s_sub_u32 s62, s62, 1
    s_mov_b32 s67, 3
    s_waitcnt vmcnt(0)
    buffer_load_dwordx4 v[144:147], v45, s[28:31], s55 offen offset:0 sc1
    buffer_load_dwordx4 v[148:151], v45, s[28:31], s55 offen offset:1024 sc1
    buffer_load_dwordx4 v[152:155], v45, s[28:31], s55 offen offset:2048 sc1
    buffer_load_dwordx4 v[156:159], v45, s[28:31], s55 offen offset:3072 sc1
    s_branch L_ge_l4
L_ge_l1:
    v_max3_u32 v17, v112, v113, v114
    v_max3_u32 v18, v115, v116, v117
    v_max3_u32 v17, v17, v118, v119
    v_max3_u32 v18, v18, v120, v121
    v_max3_u32 v17, v17, v122, v123
    v_max3_u32 v18, v18, v124, v125
    v_max3_u32 v17, v17, v126, v127
    v_max_u32 v17, v17, v18
    v_cmp_eq_u32 vcc, -1, v17
    s_cbranch_vccz L_ge_l2
    buffer_load_dwordx4 v[112:115], v45, s[28:31], s53 offen offset:0 sc1
    buffer_load_dwordx4 v[116:119], v45, s[28:31], s53 offen offset:1024 sc1
    buffer_load_dwordx4 v[120:123], v45, s[28:31], s53 offen offset:2048 sc1
    buffer_load_dwordx4 v[124:127], v45, s[28:31], s53 offen offset:3072 sc1
L_ge_l2:
    v_max3_u32 v17, v128, v129, v130
    v_max3_u32 v18, v131, v132, v133
    v_max3_u32 v17, v17, v134, v135
    v_max3_u32 v18, v18, v136, v137
    v_max3_u32 v17, v17, v138, v139
    v_max3_u32 v18, v18, v140, v141
    v_max3_u32 v17, v17, v142, v143
    v_max_u32 v17, v17, v18
    v_cmp_eq_u32 vcc, -1, v17
    s_cbranch_vccz L_ge_l3
    buffer_load_dwordx4 v[128:131], v45, s[28:31], s54 offen offset:0 sc1
    buffer_load_dwordx4 v[132:135], v45, s[28:31], s54 offen offset:1024 sc1
    buffer_load_dwordx4 v[136:139], v45, s[28:31], s54 offen offset:2048 sc1
    buffer_load_dwordx4 v[140:143], v45, s[28:31], s54 offen offset:3072 sc1
L_ge_l3:
    v_max3_u32 v17, v144, v145, v146
    v_max3_u32 v18, v147, v148, v149
    v_max3_u32 v17, v17, v150, v151
    v_max3_u32 v18, v18, v152, v153
    v_max3_u32 v17, v17, v154, v155
    v_max3_u32 v18, v18, v156, v157
    v_max3_u32 v17, v17, v158, v159
    v_max_u32 v17, v17, v18
    v_cmp_eq_u32 vcc, -1, v17
    s_cbranch_vccz L_ge_l4
    buffer_load_dwordx4 v[144:147], v45, s[28:31], s55 offen offset:0 sc1
    buffer_load_dwordx4 v[148:151], v45, s[28:31], s55 offen offset:1024 sc1
    buffer_load_dwordx4 v[152:155], v45, s[28:31], s55 offen offset:2048 sc1
    buffer_load_dwordx4 v[156:159], v45, s[28:31], s55 offen offset:3072 sc1
L_ge_l4:
    s_waitcnt vmcnt(0)
    s_cmp_eq_u32 s67, 0
    s_cbranch_scc1 L_ge_c0
    s_cmp_eq_u32 s67, 1
    s_cbranch_scc1 L_ge_c1
    s_cmp_eq_u32 s67, 2
    s_cbranch_scc1 L_ge_c2
    s_branch L_ge_c3
L_gk:
    v_lshrrev_b32 v24, 4, v0
    v_and_b32 v25, 7, v0
    v_xor_b32 v25, v25, v24
    v_lshlrev_b32 v25, 4, v25
    v_lshrrev_b32 v26, 3, v0
    v_mul_u32_u24 v26, 896, v26
    v_add_u32 v1, v26, v25
    v_xor_b32 v25, 64, v25
    v_add_u32 v2, v26, v25
    v_add_u32 v2, 6144, v2
    v_add_u32 v3, 12288, v1
    v_add_u32 v4, 12288, v2
    s_lshl_b32 s52, s46, 2
    s_add_u32 s52, s52, s45
    s_mul_i32 s52, s52, 28672
    s_lshl_b32 s55, s45, 12
    s_mov_b32 s53, s55
    s_waitcnt lgkmcnt(0)
    s_mov_b32 m0, s53
    s_add_u32 s53, s53, 16384
    buffer_load_dwordx4 v1, s[4:7], s52 offen offset:0 lds
    buffer_load_dwordx4 v2, s[4:7], s52 offen offset:1024 lds
    buffer_load_dwordx4 v3, s[4:7], s52 offen offset:2048 lds
    buffer_load_dwordx4 v4, s[4:7], s52 offen offset:3072 lds
    s_add_u32 s52, s52, 128
    s_mov_b32 m0, s53
    s_add_u32 s53, s53, 16384
    buffer_load_dwordx4 v1, s[4:7], s52 offen offset:0 lds
    buffer_load_dwordx4 v2, s[4:7], s52 offen offset:1024 lds
    buffer_load_dwordx4 v3, s[4:7], s52 offen offset:2048 lds
    buffer_load_dwordx4 v4, s[4:7], s52 offen offset:3072 lds
    s_add_u32 s52, s52, 128
    s_mov_b32 m0, s53
    s_add_u32 s53, s53, 16384
    buffer_load_dwordx4 v1, s[4:7], s52 offen offset:0 lds
    buffer_load_dwordx4 v2, s[4:7], s52 offen offset:1024 lds
    buffer_load_dwordx4 v3, s[4:7], s52 offen offset:2048 lds
    buffer_load_dwordx4 v4, s[4:7], s52 offen offset:3072 lds
    s_add_u32 s52, s52, 128
    s_mov_b32 m0, s53
    s_add_u32 s53, s53, 16384
    buffer_load_dwordx4 v1, s[4:7], s52 offen offset:0 lds
    buffer_load_dwordx4 v2, s[4:7], s52 offen offset:1024 lds
    buffer_load_dwordx4 v3, s[4:7], s52 offen offset:2048 lds
    buffer_load_dwordx4 v4, s[4:7], s52 offen offset:3072 lds
    s_add_u32 s52, s52, 128
    v_and_b32 v24, 31, v0
    v_bfe_u32 v25, v0, 1, 3
    v_xor_b32 v25, v25, v31
    v_lshlrev_b32 v25, 4, v25
    v_lshl_add_u32 v30, v24, 7, v25
    v_bfe_u32 v28, v0, 2, 2
    v_bfe_u32 v24, v0, 4, 1
    v_and_b32 v25, 3, v0
    v_lshlrev_b32 v25, 3, v25
    v_lshl_add_u32 v27, v24, 5, v25
    v_add_u32 v9, s55, v30
    v_xor_b32 v10, 32, v9
    v_xor_b32 v11, 64, v9
    v_xor_b32 v12, 96, v9
    v_add_u32 v14, 0x10000, v9
    v_add_u32 v15, 0x10000, v10
    v_add_u32 v16, 0x10000, v11
    v_add_u32 v17, 0x10000, v12
    v_lshl_add_u32 v18, v31, 3, v28
    v_mul_u32_u24 v18, 56, v18
    v_add_u32 v13, v18, v27
    v_add_u32 v13, 122880, v13
    v_lshlrev_b32 v6, 4, v31
    v_add_u32 v6, 151552, v6
    s_barrier
    s_setprio 1
    s_mov_b32 m0, s53
    s_add_u32 s53, s53, 16384
    buffer_load_dwordx4 v1, s[4:7], s52 offen offset:0 lds
    buffer_load_dwordx4 v2, s[4:7], s52 offen offset:1024 lds
    buffer_load_dwordx4 v3, s[4:7], s52 offen offset:2048 lds
    buffer_load_dwordx4 v4, s[4:7], s52 offen offset:3072 lds
    s_add_u32 s52, s52, 128
    s_mov_b32 m0, s53
    s_add_u32 s53, s53, 16384
    buffer_load_dwordx4 v1, s[4:7], s52 offen offset:0 lds
    buffer_load_dwordx4 v2, s[4:7], s52 offen offset:1024 lds
    buffer_load_dwordx4 v3, s[4:7], s52 offen offset:2048 lds
    buffer_load_dwordx4 v4, s[4:7], s52 offen offset:3072 lds
    s_add_u32 s52, s52, 128
    s_mov_b32 m0, s53
    s_add_u32 s53, s53, 16384
    buffer_load_dwordx4 v1, s[4:7], s52 offen offset:0 lds
    buffer_load_dwordx4 v2, s[4:7], s52 offen offset:1024 lds
    buffer_load_dwordx4 v3, s[4:7], s52 offen offset:2048 lds
    buffer_load_dwordx4 v4, s[4:7], s52 offen offset:3072 lds
    s_add_u32 s52, s52, 128
    s_cmp_eq_u32 s47, 15
    s_cbranch_scc1 L_gk_lv
    s_waitcnt vmcnt(24)
    ds_read_b128 v[64:67], v9 offset:0
    ds_read_b64_tr_b16 v[80:81], v13 offset:0
    ds_read_b64_tr_b16 v[82:83], v13 offset:224
    ds_read_b128 v[96:99], v6 offset:0
    ds_read_b128 v[68:71], v10 offset:0
    ds_read_b64_tr_b16 v[84:85], v13 offset:896
    ds_read_b64_tr_b16 v[86:87], v13 offset:1120
    ds_read_b128 v[100:103], v6 offset:32
    ds_read_b128 v[72:75], v11 offset:0
    ds_read_b64_tr_b16 v[88:89], v13 offset:1792
    ds_read_b64_tr_b16 v[90:91], v13 offset:2016
    ds_read_b128 v[104:107], v6 offset:64
    s_waitcnt lgkmcnt(8)
    v_mfma_f32_32x32x16_bf16 v[128:143], v[80:83], v[64:67], 0
    v_mfma_f32_32x32x16_bf16 v[160:175], v[96:99], v[64:67], 0
    ds_read_b128 v[76:79], v12 offset:0
    ds_read_b64_tr_b16 v[92:93], v13 offset:2688
    ds_read_b64_tr_b16 v[94:95], v13 offset:2912
    ds_read_b128 v[108:111], v6 offset:96
    s_waitcnt lgkmcnt(8)
    v_mfma_f32_32x32x16_bf16 v[128:143], v[84:87], v[68:71], v[128:143]
    v_mfma_f32_32x32x16_bf16 v[160:175], v[100:103], v[68:71], v[160:175]
    s_waitcnt vmcnt(20)
    ds_read_b128 v[64:67], v9 offset:16384
    ds_read_b64_tr_b16 v[80:81], v13 offset:3584
    ds_read_b64_tr_b16 v[82:83], v13 offset:3808
    ds_read_b128 v[96:99], v6 offset:128
    s_waitcnt lgkmcnt(8)
    v_mfma_f32_32x32x16_bf16 v[128:143], v[88:91], v[72:75], v[128:143]
    v_mfma_f32_32x32x16_bf16 v[160:175], v[104:107], v[72:75], v[160:175]
    ds_read_b128 v[68:71], v10 offset:16384
    ds_read_b64_tr_b16 v[84:85], v13 offset:4480
    ds_read_b64_tr_b16 v[86:87], v13 offset:4704
    ds_read_b128 v[100:103], v6 offset:160
    s_waitcnt lgkmcnt(8)
    v_mfma_f32_32x32x16_bf16 v[128:143], v[92:95], v[76:79], v[128:143]
    v_mfma_f32_32x32x16_bf16 v[160:175], v[108:111], v[76:79], v[160:175]
    ds_read_b128 v[72:75], v11 offset:16384
    ds_read_b64_tr_b16 v[88:89], v13 offset:5376
    ds_read_b64_tr_b16 v[90:91], v13 offset:5600
    ds_read_b128 v[104:107], v6 offset:192
    s_waitcnt lgkmcnt(8)
    v_mfma_f32_32x32x16_bf16 v[128:143], v[80:83], v[64:67], v[128:143]
    v_mfma_f32_32x32x16_bf16 v[160:175], v[96:99], v[64:67], v[160:175]
    ds_read_b128 v[76:79], v12 offset:16384
    ds_read_b64_tr_b16 v[92:93], v13 offset:6272
    ds_read_b64_tr_b16 v[94:95], v13 offset:6496
    ds_read_b128 v[108:111], v6 offset:224
    s_waitcnt lgkmcnt(8)
    v_mfma_f32_32x32x16_bf16 v[128:143], v[84:87], v[68:71], v[128:143]
    v_mfma_f32_32x32x16_bf16 v[160:175], v[100:103], v[68:71], v[160:175]
    s_waitcnt vmcnt(16)
    ds_read_b128 v[64:67], v9 offset:32768
    ds_read_b64_tr_b16 v[80:81], v13 offset:7168
    ds_read_b64_tr_b16 v[82:83], v13 offset:7392
    ds_read_b128 v[96:99], v6 offset:256
    s_waitcnt lgkmcnt(8)
    v_mfma_f32_32x32x16_bf16 v[128:143], v[88:91], v[72:75], v[128:143]
    v_mfma_f32_32x32x16_bf16 v[160:175], v[104:107], v[72:75], v[160:175]
    ds_read_b128 v[68:71], v10 offset:32768
    ds_read_b64_tr_b16 v[84:85], v13 offset:8064
    ds_read_b64_tr_b16 v[86:87], v13 offset:8288
    ds_read_b128 v[100:103], v6 offset:288
    s_waitcnt lgkmcnt(8)
    v_mfma_f32_32x32x16_bf16 v[128:143], v[92:95], v[76:79], v[128:143]
    v_mfma_f32_32x32x16_bf16 v[160:175], v[108:111], v[76:79], v[160:175]
    ds_read_b128 v[72:75], v11 offset:32768
    ds_read_b64_tr_b16 v[88:89], v13 offset:8960
    ds_read_b64_tr_b16 v[90:91], v13 offset:9184
    ds_read_b128 v[104:107], v6 offset:320
    s_waitcnt lgkmcnt(8)
    v_mfma_f32_32x32x16_bf16 v[128:143], v[80:83], v[64:67], v[128:143]
    v_mfma_f32_32x32x16_bf16 v[160:175], v[96:99], v[64:67], v[160:175]
    ds_read_b128 v[76:79], v12 offset:32768
    ds_read_b64_tr_b16 v[92:93], v13 offset:9856
    ds_read_b64_tr_b16 v[94:95], v13 offset:10080
    ds_read_b128 v[108:111], v6 offset:352
    s_waitcnt lgkmcnt(8)
    v_mfma_f32_32x32x16_bf16 v[128:143], v[84:87], v[68:71], v[128:143]
    v_mfma_f32_32x32x16_bf16 v[160:175], v[100:103], v[68:71], v[160:175]
    s_waitcnt vmcnt(12)
    ds_read_b128 v[64:67], v9 offset:49152
    ds_read_b64_tr_b16 v[80:81], v13 offset:10752
    ds_read_b64_tr_b16 v[82:83], v13 offset:10976
    ds_read_b128 v[96:99], v6 offset:384
    s_waitcnt lgkmcnt(8)
    v_mfma_f32_32x32x16_bf16 v[128:143], v[88:91], v[72:75], v[128:143]
    v_mfma_f32_32x32x16_bf16 v[160:175], v[104:107], v[72:75], v[160:175]
    ds_read_b128 v[68:71], v10 offset:49152
    ds_read_b64_tr_b16 v[84:85], v13 offset:11648
    ds_read_b64_tr_b16 v[86:87], v13 offset:11872
    ds_read_b128 v[100:103], v6 offset:416
    s_waitcnt lgkmcnt(8)
    v_mfma_f32_32x32x16_bf16 v[128:143], v[92:95], v[76:79], v[128:143]
    v_mfma_f32_32x32x16_bf16 v[160:175], v[108:111], v[76:79], v[160:175]
    ds_read_b128 v[72:75], v11 offset:49152
    ds_read_b64_tr_b16 v[88:89], v13 offset:12544
    ds_read_b64_tr_b16 v[90:91], v13 offset:12768
    ds_read_b128 v[104:107], v6 offset:448
    s_waitcnt lgkmcnt(8)
    v_mfma_f32_32x32x16_bf16 v[128:143], v[80:83], v[64:67], v[128:143]
    v_mfma_f32_32x32x16_bf16 v[160:175], v[96:99], v[64:67], v[160:175]
    ds_read_b128 v[76:79], v12 offset:49152
    ds_read_b64_tr_b16 v[92:93], v13 offset:13440
    ds_read_b64_tr_b16 v[94:95], v13 offset:13664
    ds_read_b128 v[108:111], v6 offset:480
    s_waitcnt lgkmcnt(8)
    v_mfma_f32_32x32x16_bf16 v[128:143], v[84:87], v[68:71], v[128:143]
    v_mfma_f32_32x32x16_bf16 v[160:175], v[100:103], v[68:71], v[160:175]
    s_waitcnt vmcnt(8)
    ds_read_b128 v[64:67], v14 offset:0
    ds_read_b64_tr_b16 v[80:81], v13 offset:14336
    ds_read_b64_tr_b16 v[82:83], v13 offset:14560
    ds_read_b128 v[96:99], v6 offset:512
    s_waitcnt lgkmcnt(8)
    v_mfma_f32_32x32x16_bf16 v[128:143], v[88:91], v[72:75], v[128:143]
    v_mfma_f32_32x32x16_bf16 v[160:175], v[104:107], v[72:75], v[160:175]
    ds_read_b128 v[68:71], v15 offset:0
    ds_read_b64_tr_b16 v[84:85], v13 offset:15232
    ds_read_b64_tr_b16 v[86:87], v13 offset:15456
    ds_read_b128 v[100:103], v6 offset:544
    s_waitcnt lgkmcnt(8)
    v_mfma_f32_32x32x16_bf16 v[128:143], v[92:95], v[76:79], v[128:143]
    v_mfma_f32_32x32x16_bf16 v[160:175], v[108:111], v[76:79], v[160:175]
    ds_read_b128 v[72:75], v16 offset:0
    ds_read_b64_tr_b16 v[88:89], v13 offset:16128
    ds_read_b64_tr_b16 v[90:91], v13 offset:16352
    ds_read_b128 v[104:107], v6 offset:576
    s_waitcnt lgkmcnt(8)
    v_mfma_f32_32x32x16_bf16 v[128:143], v[80:83], v[64:67], v[128:143]
    v_mfma_f32_32x32x16_bf16 v[160:175], v[96:99], v[64:67], v[160:175]
    ds_read_b128 v[76:79], v17 offset:0
    ds_read_b64_tr_b16 v[92:93], v13 offset:17024
    ds_read_b64_tr_b16 v[94:95], v13 offset:17248
    ds_read_b128 v[108:111], v6 offset:608
    s_waitcnt lgkmcnt(8)
    v_mfma_f32_32x32x16_bf16 v[128:143], v[84:87], v[68:71], v[128:143]
    v_mfma_f32_32x32x16_bf16 v[160:175], v[100:103], v[68:71], v[160:175]
    s_waitcnt vmcnt(4)
    ds_read_b128 v[64:67], v14 offset:16384
    ds_read_b64_tr_b16 v[80:81], v13 offset:17920
    ds_read_b64_tr_b16 v[82:83], v13 offset:18144
    ds_read_b128 v[96:99], v6 offset:640
    s_waitcnt lgkmcnt(8)
    v_mfma_f32_32x32x16_bf16 v[128:143], v[88:91], v[72:75], v[128:143]
    v_mfma_f32_32x32x16_bf16 v[160:175], v[104:107], v[72:75], v[160:175]
    ds_read_b128 v[68:71], v15 offset:16384
    ds_read_b64_tr_b16 v[84:85], v13 offset:18816
    ds_read_b64_tr_b16 v[86:87], v13 offset:19040
    ds_read_b128 v[100:103], v6 offset:672
    s_waitcnt lgkmcnt(8)
    v_mfma_f32_32x32x16_bf16 v[128:143], v[92:95], v[76:79], v[128:143]
    v_mfma_f32_32x32x16_bf16 v[160:175], v[108:111], v[76:79], v[160:175]
    ds_read_b128 v[72:75], v16 offset:16384
    ds_read_b64_tr_b16 v[88:89], v13 offset:19712
    ds_read_b64_tr_b16 v[90:91], v13 offset:19936
    ds_read_b128 v[104:107], v6 offset:704
    s_waitcnt lgkmcnt(8)
    v_mfma_f32_32x32x16_bf16 v[128:143], v[80:83], v[64:67], v[128:143]
    v_mfma_f32_32x32x16_bf16 v[160:175], v[96:99], v[64:67], v[160:175]
    ds_read_b128 v[76:79], v17 offset:16384
    ds_read_b64_tr_b16 v[92:93], v13 offset:20608
    ds_read_b64_tr_b16 v[94:95], v13 offset:20832
    ds_read_b128 v[108:111], v6 offset:736
    s_waitcnt lgkmcnt(8)
    v_mfma_f32_32x32x16_bf16 v[128:143], v[84:87], v[68:71], v[128:143]
    v_mfma_f32_32x32x16_bf16 v[160:175], v[100:103], v[68:71], v[160:175]
    s_waitcnt vmcnt(0)
    ds_read_b128 v[64:67], v14 offset:32768
    ds_read_b64_tr_b16 v[80:81], v13 offset:21504
    ds_read_b64_tr_b16 v[82:83], v13 offset:21728
    ds_read_b128 v[96:99], v6 offset:768
    s_waitcnt lgkmcnt(8)
    v_mfma_f32_32x32x16_bf16 v[128:143], v[88:91], v[72:75], v[128:143]
    v_mfma_f32_32x32x16_bf16 v[160:175], v[104:107], v[72:75], v[160:175]
    ds_read_b128 v[68:71], v15 offset:32768
    ds_read_b64_tr_b16 v[84:85], v13 offset:22400
    ds_read_b64_tr_b16 v[86:87], v13 offset:22624
    ds_read_b128 v[100:103], v6 offset:800
    s_waitcnt lgkmcnt(8)
    v_mfma_f32_32x32x16_bf16 v[128:143], v[92:95], v[76:79], v[128:143]
    v_mfma_f32_32x32x16_bf16 v[160:175], v[108:111], v[76:79], v[160:175]
    ds_read_b128 v[72:75], v16 offset:32768
    ds_read_b64_tr_b16 v[88:89], v13 offset:23296
    ds_read_b64_tr_b16 v[90:91], v13 offset:23520
    ds_read_b128 v[104:107], v6 offset:832
    s_waitcnt lgkmcnt(8)
    v_mfma_f32_32x32x16_bf16 v[128:143], v[80:83], v[64:67], v[128:143]
    v_mfma_f32_32x32x16_bf16 v[160:175], v[96:99], v[64:67], v[160:175]
    ds_read_b128 v[76:79], v17 offset:32768
    ds_read_b64_tr_b16 v[92:93], v13 offset:24192
    ds_read_b64_tr_b16 v[94:95], v13 offset:24416
    ds_read_b128 v[108:111], v6 offset:864
    s_waitcnt lgkmcnt(8)
    v_mfma_f32_32x32x16_bf16 v[128:143], v[84:87], v[68:71], v[128:143]
    v_mfma_f32_32x32x16_bf16 v[160:175], v[100:103], v[68:71], v[160:175]
    s_waitcnt lgkmcnt(4)
    v_mfma_f32_32x32x16_bf16 v[128:143], v[88:91], v[72:75], v[128:143]
    v_mfma_f32_32x32x16_bf16 v[160:175], v[104:107], v[72:75], v[160:175]
    s_waitcnt lgkmcnt(0)
    v_mfma_f32_32x32x16_bf16 v[128:143], v[92:95], v[76:79], v[128:143]
    v_mfma_f32_32x32x16_bf16 v[160:175], v[108:111], v[76:79], v[160:175]
    s_branch L_gk_le
L_gk_lv:
    s_waitcnt vmcnt(24)
    ds_read_b128 v[64:67], v9 offset:0
    ds_read_b64_tr_b16 v[80:81], v13 offset:0
    ds_read_b64_tr_b16 v[82:83], v13 offset:224
    ds_read_b128 v[68:71], v10 offset:0
    ds_read_b64_tr_b16 v[84:85], v13 offset:896
    ds_read_b64_tr_b16 v[86:87], v13 offset:1120
    ds_read_b128 v[72:75], v11 offset:0
    ds_read_b64_tr_b16 v[88:89], v13 offset:1792
    ds_read_b64_tr_b16 v[90:91], v13 offset:2016
    s_waitcnt lgkmcnt(6)
    v_mfma_f32_32x32x16_bf16 v[128:143], v[64:67], v[80:83], 0
    ds_read_b128 v[76:79], v12 offset:0
    ds_read_b64_tr_b16 v[92:93], v13 offset:2688
    ds_read_b64_tr_b16 v[94:95], v13 offset:2912
    s_waitcnt lgkmcnt(6)
    v_mfma_f32_32x32x16_bf16 v[128:143], v[68:71], v[84:87], v[128:143]
    s_waitcnt vmcnt(20)
    ds_read_b128 v[64:67], v9 offset:16384
    ds_read_b64_tr_b16 v[80:81], v13 offset:3584
    ds_read_b64_tr_b16 v[82:83], v13 offset:3808
    s_waitcnt lgkmcnt(6)
    v_mfma_f32_32x32x16_bf16 v[128:143], v[72:75], v[88:91], v[128:143]
    ds_read_b128 v[68:71], v10 offset:16384
    ds_read_b64_tr_b16 v[84:85], v13 offset:4480
    ds_read_b64_tr_b16 v[86:87], v13 offset:4704
    s_waitcnt lgkmcnt(6)
    v_mfma_f32_32x32x16_bf16 v[128:143], v[76:79], v[92:95], v[128:143]
    ds_read_b128 v[72:75], v11 offset:16384
    ds_read_b64_tr_b16 v[88:89], v13 offset:5376
    ds_read_b64_tr_b16 v[90:91], v13 offset:5600
    s_waitcnt lgkmcnt(6)
    v_mfma_f32_32x32x16_bf16 v[128:143], v[64:67], v[80:83], v[128:143]
    ds_read_b128 v[76:79], v12 offset:16384
    ds_read_b64_tr_b16 v[92:93], v13 offset:6272
    ds_read_b64_tr_b16 v[94:95], v13 offset:6496
    s_waitcnt lgkmcnt(6)
    v_mfma_f32_32x32x16_bf16 v[128:143], v[68:71], v[84:87], v[128:143]
    s_waitcnt vmcnt(16)
    ds_read_b128 v[64:67], v9 offset:32768
    ds_read_b64_tr_b16 v[80:81], v13 offset:7168
    ds_read_b64_tr_b16 v[82:83], v13 offset:7392
    s_waitcnt lgkmcnt(6)
    v_mfma_f32_32x32x16_bf16 v[128:143], v[72:75], v[88:91], v[128:143]
    ds_read_b128 v[68:71], v10 offset:32768
    ds_read_b64_tr_b16 v[84:85], v13 offset:8064
    ds_read_b64_tr_b16 v[86:87], v13 offset:8288
    s_waitcnt lgkmcnt(6)
    v_mfma_f32_32x32x16_bf16 v[128:143], v[76:79], v[92:95], v[128:143]
    ds_read_b128 v[72:75], v11 offset:32768
    ds_read_b64_tr_b16 v[88:89], v13 offset:8960
    ds_read_b64_tr_b16 v[90:91], v13 offset:9184
    s_waitcnt lgkmcnt(6)
    v_mfma_f32_32x32x16_bf16 v[128:143], v[64:67], v[80:83], v[128:143]
    ds_read_b128 v[76:79], v12 offset:32768
    ds_read_b64_tr_b16 v[92:93], v13 offset:9856
    ds_read_b64_tr_b16 v[94:95], v13 offset:10080
    s_waitcnt lgkmcnt(6)
    v_mfma_f32_32x32x16_bf16 v[128:143], v[68:71], v[84:87], v[128:143]
    s_waitcnt vmcnt(12)
    ds_read_b128 v[64:67], v9 offset:49152
    ds_read_b64_tr_b16 v[80:81], v13 offset:10752
    ds_read_b64_tr_b16 v[82:83], v13 offset:10976
    s_waitcnt lgkmcnt(6)
    v_mfma_f32_32x32x16_bf16 v[128:143], v[72:75], v[88:91], v[128:143]
    ds_read_b128 v[68:71], v10 offset:49152
    ds_read_b64_tr_b16 v[84:85], v13 offset:11648
    ds_read_b64_tr_b16 v[86:87], v13 offset:11872
    s_waitcnt lgkmcnt(6)
    v_mfma_f32_32x32x16_bf16 v[128:143], v[76:79], v[92:95], v[128:143]
    ds_read_b128 v[72:75], v11 offset:49152
    ds_read_b64_tr_b16 v[88:89], v13 offset:12544
    ds_read_b64_tr_b16 v[90:91], v13 offset:12768
    s_waitcnt lgkmcnt(6)
    v_mfma_f32_32x32x16_bf16 v[128:143], v[64:67], v[80:83], v[128:143]
    ds_read_b128 v[76:79], v12 offset:49152
    ds_read_b64_tr_b16 v[92:93], v13 offset:13440
    ds_read_b64_tr_b16 v[94:95], v13 offset:13664
    s_waitcnt lgkmcnt(6)
    v_mfma_f32_32x32x16_bf16 v[128:143], v[68:71], v[84:87], v[128:143]
    s_waitcnt vmcnt(8)
    ds_read_b128 v[64:67], v14 offset:0
    ds_read_b64_tr_b16 v[80:81], v13 offset:14336
    ds_read_b64_tr_b16 v[82:83], v13 offset:14560
    s_waitcnt lgkmcnt(6)
    v_mfma_f32_32x32x16_bf16 v[128:143], v[72:75], v[88:91], v[128:143]
    ds_read_b128 v[68:71], v15 offset:0
    ds_read_b64_tr_b16 v[84:85], v13 offset:15232
    ds_read_b64_tr_b16 v[86:87], v13 offset:15456
    s_waitcnt lgkmcnt(6)
    v_mfma_f32_32x32x16_bf16 v[128:143], v[76:79], v[92:95], v[128:143]
    ds_read_b128 v[72:75], v16 offset:0
    ds_read_b64_tr_b16 v[88:89], v13 offset:16128
    ds_read_b64_tr_b16 v[90:91], v13 offset:16352
    s_waitcnt lgkmcnt(6)
    v_mfma_f32_32x32x16_bf16 v[128:143], v[64:67], v[80:83], v[128:143]
    ds_read_b128 v[76:79], v17 offset:0
    ds_read_b64_tr_b16 v[92:93], v13 offset:17024
    ds_read_b64_tr_b16 v[94:95], v13 offset:17248
    s_waitcnt lgkmcnt(6)
    v_mfma_f32_32x32x16_bf16 v[128:143], v[68:71], v[84:87], v[128:143]
    s_waitcnt vmcnt(4)
    ds_read_b128 v[64:67], v14 offset:16384
    ds_read_b64_tr_b16 v[80:81], v13 offset:17920
    ds_read_b64_tr_b16 v[82:83], v13 offset:18144
    s_waitcnt lgkmcnt(6)
    v_mfma_f32_32x32x16_bf16 v[128:143], v[72:75], v[88:91], v[128:143]
    ds_read_b128 v[68:71], v15 offset:16384
    ds_read_b64_tr_b16 v[84:85], v13 offset:18816
    ds_read_b64_tr_b16 v[86:87], v13 offset:19040
    s_waitcnt lgkmcnt(6)
    v_mfma_f32_32x32x16_bf16 v[128:143], v[76:79], v[92:95], v[128:143]
    ds_read_b128 v[72:75], v16 offset:16384
    ds_read_b64_tr_b16 v[88:89], v13 offset:19712
    ds_read_b64_tr_b16 v[90:91], v13 offset:19936
    s_waitcnt lgkmcnt(6)
    v_mfma_f32_32x32x16_bf16 v[128:143], v[64:67], v[80:83], v[128:143]
    ds_read_b128 v[76:79], v17 offset:16384
    ds_read_b64_tr_b16 v[92:93], v13 offset:20608
    ds_read_b64_tr_b16 v[94:95], v13 offset:20832
    s_waitcnt lgkmcnt(6)
    v_mfma_f32_32x32x16_bf16 v[128:143], v[68:71], v[84:87], v[128:143]
    s_waitcnt vmcnt(0)
    ds_read_b128 v[64:67], v14 offset:32768
    ds_read_b64_tr_b16 v[80:81], v13 offset:21504
    ds_read_b64_tr_b16 v[82:83], v13 offset:21728
    s_waitcnt lgkmcnt(6)
    v_mfma_f32_32x32x16_bf16 v[128:143], v[72:75], v[88:91], v[128:143]
    ds_read_b128 v[68:71], v15 offset:32768
    ds_read_b64_tr_b16 v[84:85], v13 offset:22400
    ds_read_b64_tr_b16 v[86:87], v13 offset:22624
    s_waitcnt lgkmcnt(6)
    v_mfma_f32_32x32x16_bf16 v[128:143], v[76:79], v[92:95], v[128:143]
    ds_read_b128 v[72:75], v16 offset:32768
    ds_read_b64_tr_b16 v[88:89], v13 offset:23296
    ds_read_b64_tr_b16 v[90:91], v13 offset:23520
    s_waitcnt lgkmcnt(6)
    v_mfma_f32_32x32x16_bf16 v[128:143], v[64:67], v[80:83], v[128:143]
    ds_read_b128 v[76:79], v17 offset:32768
    ds_read_b64_tr_b16 v[92:93], v13 offset:24192
    ds_read_b64_tr_b16 v[94:95], v13 offset:24416
    s_waitcnt lgkmcnt(6)
    v_mfma_f32_32x32x16_bf16 v[128:143], v[68:71], v[84:87], v[128:143]
    s_waitcnt lgkmcnt(3)
    v_mfma_f32_32x32x16_bf16 v[128:143], v[72:75], v[88:91], v[128:143]
    s_waitcnt lgkmcnt(0)
    v_mfma_f32_32x32x16_bf16 v[128:143], v[76:79], v[92:95], v[128:143]
L_gk_le:
    s_lshl_b32 s56, s46, 2
    s_add_u32 s56, s56, s45
    s_lshl_b32 s57, s56, 7
    s_lshl_b32 s56, s56, 12
    s_add_u32 s57, s57, 262144
    v_and_b32 v17, 31, v0
    s_nop 3
    s_cmp_eq_u32 s47, 15
    s_cbranch_scc1 L_gk_v
    v_cmp_eq_u32 vcc, 0, v31
    v_cvt_pk_bf16_f32 v32, v128, v129
    v_cvt_pk_bf16_f32 v33, v130, v131
    v_cvt_pk_bf16_f32 v34, v132, v133
    v_cvt_pk_bf16_f32 v35, v134, v135
    v_cvt_pk_bf16_f32 v36, v136, v137
    v_cvt_pk_bf16_f32 v37, v138, v139
    v_cvt_pk_bf16_f32 v38, v140, v141
    v_cvt_pk_bf16_f32 v39, v142, v143
    v_mov_b32 v18, 0x3f80
    v_cndmask_b32 v38, v18, v38, vcc
    v_cndmask_b32 v39, 0, v39, vcc
    buffer_store_dwordx4 v[32:35], v29, s[28:31], s56 offen sc1
    buffer_store_dwordx4 v[36:39], v29, s[28:31], s56 offen offset:1024 sc1
    v_mul_f32 v18, 0xbfb8aa3b, v160
    v_exp_f32 v18, v18
    v_lshlrev_b32 v17, 2, v17
    v_add_f32 v18, 1.0, v18
    v_rcp_f32 v18, v18
    s_mov_b32 exec_hi, 0
    buffer_store_dword v18, v17, s[28:31], s57 offen sc1
    s_mov_b64 exec, -1
    s_branch L_gk_pub
L_gk_v:
    v_cmp_gt_u32 vcc, 28, v17
    v_cmp_eq_u32 s[66:67], 28, v17
    v_mov_b32 v18, 0x3f803f80
    v_mov_b32 v19, 0
    v_cndmask_b32 v18, v19, v18, s[66:67]
    v_cvt_pk_bf16_f32 v32, v128, v129
    v_cvt_pk_bf16_f32 v33, v130, v131
    v_cvt_pk_bf16_f32 v34, v132, v133
    v_cvt_pk_bf16_f32 v35, v134, v135
    v_cvt_pk_bf16_f32 v36, v136, v137
    v_cvt_pk_bf16_f32 v37, v138, v139
    v_cvt_pk_bf16_f32 v38, v140, v141
    v_cvt_pk_bf16_f32 v39, v142, v143
    v_cndmask_b32 v32, v18, v32, vcc
    v_cndmask_b32 v33, v18, v33, vcc
    v_cndmask_b32 v34, v18, v34, vcc
    v_cndmask_b32 v35, v18, v35, vcc
    v_cndmask_b32 v36, v18, v36, vcc
    v_cndmask_b32 v37, v18, v37, vcc
    v_cndmask_b32 v38, v18, v38, vcc
    v_cndmask_b32 v39, v18, v39, vcc
    buffer_store_dwordx4 v[32:35], v29, s[28:31], s56 offen offset:2048 sc1
    buffer_store_dwordx4 v[36:39], v29, s[28:31], s56 offen offset:3072 sc1
L_gk_pub:
    v_mov_b32 v25, 163792
    v_mov_b32 v26, 1
    s_waitcnt vmcnt(0)
    s_mov_b64 exec, 1
    ds_add_rtn_u32 v24, v25, v26 offset:12
    s_waitcnt lgkmcnt(0)
    v_readfirstlane_b32 s63, v24
    s_nop 0
    s_cmp_lg_u32 s63, 3
    s_cbranch_scc1 L_gk_nosig
    v_mov_b32 v24, 1
    buffer_atomic_add v24, off, s[36:39], 0 sc0 sc1
    s_waitcnt vmcnt(0)
    v_readfirstlane_b32 s63, v24
    s_nop 0
    s_cmp_lg_u32 s63, 31
    s_cbranch_scc1 L_gk_nosig
    buffer_store_dword v26, off, s[36:39], 0 offset:128 sc1
L_gk_nosig:
    s_mov_b64 exec, -1
    s_barrier
    s_setprio 0
    s_lshl_b32 s65, s46, 2
    s_add_u32 s65, s65, s45
    s_lshl_b32 s65, s65, 4
    s_add_u32 s65, s65, s50
    s_lshl_b32 s65, s65, 11
    s_add_u32 s65, s65, 524288
    v_mov_b32 v56, -1
    v_mov_b32 v57, -1
    v_mov_b32 v58, -1
    v_mov_b32 v59, -1
    buffer_store_dwordx4 v[56:59], v29, s[28:31], s65 offen offset:0 sc1
    buffer_store_dwordx4 v[56:59], v29, s[28:31], s65 offen offset:1024 sc1
    s_barrier
    s_lshl_b32 s62, s46, 1
    s_add_u32 s62, s62, s47
    s_sub_u32 s62, s62, 14
    s_lshl_b32 s62, s62, 2
    s_add_u32 s62, s62, s45
    s_mul_i32 s63, s62, 12544
    s_mul_i32 s62, s62, 3200
    v_lshlrev_b32 v60, 7, v0
    s_add_u32 s64, s63, 6272
    s_mov_b32 exec_hi, 0x1ffff
    buffer_load_dword v61, v60, s[20:23], s63 offen
    buffer_load_dword v61, v60, s[20:23], s64 offen
    s_mov_b32 exec_hi, 0
    s_mov_b32 exec_lo, 0x1ffffff
    buffer_load_dword v61, v60, s[24:27], s62 offen
    s_mov_b64 exec, -1
    s_setprio 3
    s_mov_b32 s62, 1048576
L_g_gok:
    ds_read_b32 v24, v25 offset:4
    s_waitcnt lgkmcnt(0)
    v_readfirstlane_b32 s63, v24
    s_sub_u32 s62, s62, 1
    s_cmp_eq_u32 s62, 0
    s_cbranch_scc1 L_g_gok_x
    s_cmp_ge_u32 s63, 1
    s_cbranch_scc1 L_g_gok_x
    s_sleep 2
    s_branch L_g_gok
L_g_gok_x:
    s_waitcnt vmcnt(0)
    s_mov_b64 exec, 1
    ds_add_rtn_u32 v24, v25, v26 offset:8
    s_waitcnt lgkmcnt(0)
    v_readfirstlane_b32 s63, v24
    s_lshl_b32 s70, s46, 4
    s_add_u32 s70, s70, s47
    s_lshl_b32 s70, s70, 7
    s_add_u32 s70, s70, 294912
    s_cmp_lg_u32 s63, 3
    s_cbranch_scc1 L_g_nosigk
    buffer_store_dword v26, off, s[28:31], s70 sc1
L_g_nosigk:
    s_mov_b64 exec, -1
    s_setprio 0
L_gend:
L_end:
    s_endpgm
.section .rodata,"a"
.p2align 6
.amdhsa_kernel gated_mix__grouped_kv_mqa__glu_gated_bilinear__prompt_kernel
  .amdhsa_next_free_vgpr 256
  .amdhsa_next_free_sgpr 102
  .amdhsa_accum_offset 256
  .amdhsa_group_segment_fixed_size 0
  .amdhsa_kernarg_size 104
  .amdhsa_user_sgpr_count 2
  .amdhsa_user_sgpr_kernarg_segment_ptr 1
  .amdhsa_system_sgpr_workgroup_id_x 1
.end_amdhsa_kernel
```
